```python
import torch

def _softmax(x, axis=-1):
    return torch.softmax(x, dim=axis)
def _gelu(x):
    return torch.nn.functional.gelu(x, approximate="tanh")
def _silu(x):
    return torch.nn.functional.silu(x)
def _sigmoid(x):
    return torch.sigmoid(x)
def _layernorm(x, axis=-1, eps=1e-5):
    m = x.mean(dim=axis, keepdim=True)
    v = x.var(dim=axis, keepdim=True, unbiased=False)
    return (x - m) / torch.sqrt(v + eps)
def _scatter_add(tgt, idx, src, axis=0):
    return tgt.clone().index_add_(axis, idx, src)
def _segment_sum(src, seg, n):
    out = torch.zeros((n,) + src.shape[1:], dtype=src.dtype)
    return out.index_add_(0, seg, src)
def _pad(x, pw):
    flat = tuple(v for pair in reversed(pw) for v in pair)
    return torch.nn.functional.pad(x, flat)

kernel_name = 'parallel_sum__spectral_gfnet__dense_activation_silu__prompt'

def setup_inputs():

    _w = (lambda a: (lambda t: t.to(torch.bfloat16) if t.is_floating_point() else t)(torch.as_tensor(a)))
    def _A_setup():
        B, S, D = 1, 2048, 512
        Df = D // 2 + 1
        return {
            "x": _w((lambda *s: torch.randn(*s, dtype=torch.bfloat16) * 0.05)(B, S, D)),
            "w_r": _w((lambda *s: torch.randn(*s, dtype=torch.bfloat16) * 0.8)(S, Df) * 0.02),
            "w_i": _w((lambda *s: torch.randn(*s, dtype=torch.bfloat16) * 0.8)(S, Df) * 0.02),
        }
    _A_in = _A_setup()

    def _B_setup():
        B, S, D, F = 1, 2048, 512, 1376
        return {
            "x": _w((lambda *s: torch.randn(*s, dtype=torch.bfloat16) * 0.05)(B, S, D)),
            "w1": _w((lambda *s: torch.randn(*s, dtype=torch.bfloat16) * 0.8)(D, F) * (D ** -0.5)),
            "w2": _w((lambda *s: torch.randn(*s, dtype=torch.bfloat16) * 0.1)(F, D) * (F ** -0.5)),
        }
    _B_in = _B_setup()

    return {
        "A_x": _A_in["x"],
        "A_w_r": _A_in["w_r"],
        "A_w_i": _A_in["w_i"],
        "B_x": _B_in["x"],
        "B_w1": _B_in["w1"],
        "B_w2": _B_in["w2"],
    }

def reference(A_x, A_w_r, A_w_i, B_x, B_w1, B_w2):
    def _A_ref(x, w_r, w_i):
        B, S, D = x.shape
        X = (lambda x, axes=(-2,-1): torch.fft.rfft2(x.float(), dim=axes))(x, axes=(-2, -1))
        W = w_r + 1j * w_i
        X = X * W
        y = (lambda x, s, axes=(-2,-1): torch.fft.irfft2(x, s=s, dim=axes).to(torch.bfloat16))(X, (S, D), axes=(-2, -1))
        return y

    def _B_ref(x, w1, w2):
        h = torch.einsum("bsd,df->bsf", x, w1)
        h = _silu(h)
        out = torch.einsum("bsf,fd->bsd", h, w2)
        return out

    x = A_x
    xn = _layernorm(x, axis=-1)
    return x + _A_ref(xn, A_w_r, A_w_i) + _B_ref(xn, B_w1, B_w2)
```

```asm
; @launch grid=(256,1,1) block=(512,1,1) lds=163712
.amdgcn_target "amdgcn-amd-amdhsa--gfx950"
.text
.globl parallel_sum__spectral_gfnet__dense_activation_silu__prompt_kernel
.p2align 8
.type parallel_sum__spectral_gfnet__dense_activation_silu__prompt_kernel,@function
parallel_sum__spectral_gfnet__dense_activation_silu__prompt_kernel:
    s_cmp_gt_u32 s2, 255
    s_cbranch_scc1 K_END
    s_load_dwordx2 s[4:5], s[0:1], 0
    s_load_dwordx2 s[24:25], s[0:1], 64
    s_load_dwordx2 s[8:9], s[0:1], 8
    s_load_dwordx2 s[12:13], s[0:1], 16
    s_load_dwordx2 s[16:17], s[0:1], 32
    s_load_dwordx2 s[20:21], s[0:1], 40
    s_load_dwordx2 s[28:29], s[0:1], 48
    s_getpc_b64 s[44:45]
K_PC:
    s_lshr_b32 s46, s2, 3
    s_lshl_b32 s46, s46, 11
    v_and_b32 v8, 63, v0
    v_lshl_add_u32 v8, v8, 5, s46
    v_cmp_gt_u32 vcc, TEXT_END-K_PC, v8
    s_mov_b32 s47, 447
    v_cmp_lt_u32 s[46:47], s47, v0
    v_mov_b32 v11, s45
    s_and_b64 exec, vcc, s[46:47]
    v_add_co_u32 v10, vcc, s44, v8
    s_nop 1
    v_addc_co_u32 v11, vcc, 0, v11, vcc
    s_cbranch_execz K_NOPF
    global_load_dword v255, v[10:11], off
K_NOPF:
    s_mov_b64 exec, -1
    v_lshrrev_b32 v8, 6, v0
    v_and_b32 v1, 63, v0
    v_readfirstlane_b32 s3, v8
    v_and_b32 v2, 15, v0
    v_bfe_u32 v3, v0, 4, 2
    v_mov_b32 v4, 0
    v_mov_b32 v5, 1
    v_mov_b32 v6, 162048
    s_lshr_b32 s61, s3, 2
    s_and_b32 s3, s3, 3
    s_and_b32 s36, s2, 7
    s_lshr_b32 s37, s2, 3
    s_mov_b32 s39, 0xffff0000
    s_mov_b32 s40, 0x80008000
    v_lshlrev_b32 v235, 4, v0
    v_lshl_add_u32 v8, v1, 2, v6
    ds_write_b32 v8, v4
    s_mov_b32 s6, 2097152
    s_mov_b32 s7, 0x20000
    s_mov_b32 s26, 268435456
    s_mov_b32 s27, 0x20000
    s_mov_b32 s10, 1052672
    s_mov_b32 s11, 0x20000
    s_mov_b32 s14, 1052672
    s_mov_b32 s15, 0x20000
    s_mov_b32 s18, 1409024
    s_mov_b32 s19, 0x20000
    s_mov_b32 s22, 1409024
    s_mov_b32 s23, 0x20000
    s_mov_b32 s30, 2097152
    s_mov_b32 s31, 0x20000
    s_cmp_eq_u32 s61, 1
    s_cbranch_scc1 G_FIRST
    s_setprio 2
    s_lshl_b32 s42, s36, 1
    s_and_b32 s44, s37, 1
    s_add_u32 s42, s42, s44
    s_lshr_b32 s43, s37, 1
    s_lshl_b32 s44, s42, 7
    s_and_b32 s45, s3, 1
    s_lshl_b32 s45, s45, 6
    s_add_u32 s44, s44, s45
    s_lshr_b32 s45, s3, 1
    s_lshl_b32 s45, s45, 4
    s_add_u32 s44, s44, s45
    s_add_u32 s44, s44, s43
    s_lshl_b32 s44, s44, 10
    s_add_u32 s45, s44, 32768
    v_and_b32 v7, 1, v3
    v_lshlrev_b32 v7, 5, v7
    v_lshl_add_u32 v7, v2, 1, v7
    v_lshrrev_b32 v8, 1, v3
    v_add_u32 v7, v7, v8
    v_lshlrev_b32 v228, 4, v7
    s_getpc_b64 s[46:47]
K_PC2:
    s_add_u32 s46, s46, K_TAB-K_PC2
    s_addc_u32 s47, s47, 0
    v_lshlrev_b32 v14, 4, v1
    v_mov_b32 v15, s47
    v_add_co_u32 v14, vcc, s46, v14
    s_nop 1
    v_addc_co_u32 v15, vcc, 0, v15, vcc
    s_waitcnt lgkmcnt(0)
    buffer_load_dwordx4 v[184:187], v228, s[4:7], s44 offen
    buffer_load_dwordx4 v[188:191], v228, s[4:7], s45 offen
    s_mov_b32 s48, 22740992
    s_load_dword s38, s[24:25], s48
    s_barrier
    s_branch F_START
G_FIRST:
    s_lshr_b32 s42, s36, 1
    s_lshl_b32 s42, s42, 2
    s_and_b32 s48, s37, 3
    s_add_u32 s42, s42, s48
    s_and_b32 s43, s36, 1
    s_lshl_b32 s43, s43, 3
    s_lshr_b32 s45, s37, 2
    s_add_u32 s43, s43, s45
    s_lshl_b32 s44, s36, 2
    s_add_u32 s44, s44, s48
    s_lshl_b32 s46, s3, 10
    v_lshlrev_b32 v15, 4, v1
    s_lshl_b32 s53, s42, 1
    s_lshr_b32 s49, s42, 2
    s_add_u32 s53, s53, s49
    s_and_b32 s53, s53, 7
    v_bfe_u32 v18, v1, 3, 2
    v_lshrrev_b32 v19, 5, v1
    v_lshlrev_b32 v18, 15, v18
    v_lshl_add_u32 v18, v19, 14, v18
    v_and_b32 v19, 7, v1
    v_xor_b32 v19, v19, v3
    v_lshl_add_u32 v48, v19, 4, v18
    v_xor_b32 v49, 64, v48
    s_lshl_b32 s50, s42, 17
    s_lshl_b32 s49, s3, 12
    s_add_u32 s50, s50, s49
    s_add_u32 s51, s49, 73728
    s_mul_i32 s48, s3, 192
    s_mul_i32 s49, s43, 192
    s_mov_b32 s59, 0x15555556
    v_add_u32 v18, s48, v1
    v_mul_hi_u32 v19, v18, s59
    v_mul_u32_u24 v20, 12, v19
    v_sub_u32 v20, v18, v20
    v_bfe_u32 v18, v19, 3, 1
    v_lshlrev_b32 v18, 1, v18
    v_xor_b32 v20, v20, v18
    v_mul_u32_u24 v19, 2752, v19
    v_lshl_add_u32 v19, v20, 4, v19
    v_add_u32 v216, s49, v19
    v_add_u32 v18, s48, v1
    v_add_u32 v18, 64, v18
    v_mul_hi_u32 v19, v18, s59
    v_mul_u32_u24 v20, 12, v19
    v_sub_u32 v20, v18, v20
    v_bfe_u32 v18, v19, 3, 1
    v_lshlrev_b32 v18, 1, v18
    v_xor_b32 v20, v20, v18
    v_mul_u32_u24 v19, 2752, v19
    v_lshl_add_u32 v19, v20, 4, v19
    v_add_u32 v217, s49, v19
    v_subrev_u32 v217, 1024, v217
    v_add_u32 v18, s48, v1
    v_add_u32 v18, 128, v18
    v_mul_hi_u32 v19, v18, s59
    v_mul_u32_u24 v20, 12, v19
    v_sub_u32 v20, v18, v20
    v_bfe_u32 v18, v19, 3, 1
    v_lshlrev_b32 v18, 1, v18
    v_xor_b32 v20, v20, v18
    v_mul_u32_u24 v19, 2752, v19
    v_lshl_add_u32 v19, v20, 4, v19
    v_add_u32 v218, s49, v19
    v_subrev_u32 v218, 2048, v218
    s_mul_i32 s52, s3, 3072
    s_lshl_b32 s48, s3, 8
    s_add_u32 s48, s48, 162304
    v_lshl_add_u32 v9, v1, 2, s48
    v_and_b32 v11, 3, v1
    v_lshlrev_b32 v11, 6, v11
    v_add_u32 v11, v11, v1
    v_lshlrev_b32 v11, 2, v11
    v_add_u32 v11, 162304, v11
    ds_write_b32 v9, v4
    s_waitcnt lgkmcnt(0)
    s_barrier
    s_cmp_gt_u32 s43, 14
    s_cbranch_scc1 G_IDLE
    s_xor_b32 s92, s53, 0
    s_lshl_b32 s92, s92, 7
    s_add_u32 s92, s92, s50
    s_add_u32 m0, s51, 0
    s_nop 0
    buffer_load_dwordx4 v48, s[4:7], s92 offen offset:0 lds
    buffer_load_dwordx4 v49, s[4:7], s92 offen offset:1024 lds
    buffer_load_dwordx4 v48, s[4:7], s92 offen offset:2048 lds
    buffer_load_dwordx4 v49, s[4:7], s92 offen offset:3072 lds
    s_xor_b32 s93, s53, 0
    s_mul_i32 s93, s93, 176128
    s_add_u32 m0, s52, 0
    s_nop 0
    buffer_load_dwordx4 v216, s[16:19], s93 offen offset:0 lds
    buffer_load_dwordx4 v217, s[16:19], s93 offen offset:1024 lds
    buffer_load_dwordx4 v218, s[16:19], s93 offen offset:2048 lds
    s_branch G_START
F_START:
    v_add_co_u32 v14, vcc, 4096, v14
    s_nop 1
    v_addc_co_u32 v15, vcc, 0, v15, vcc
    global_load_dwordx4 v[120:123], v[14:15], off offset:0
    global_load_dwordx4 v[124:127], v[14:15], off offset:1024
    global_load_dwordx4 v[128:131], v[14:15], off offset:2048
    global_load_dwordx4 v[132:135], v[14:15], off offset:3072
    v_add_co_u32 v14, vcc, 4096, v14
    s_nop 1
    v_addc_co_u32 v15, vcc, 0, v15, vcc
    s_lshl_b32 s48, s42, 4
    s_add_u32 s48, s48, s43
    s_lshr_b32 s49, s48, 6
    s_lshl_b32 s49, s49, 4
    s_bfe_u32 s50, s48, 0x20004
    s_lshl_b32 s50, s50, 8
    s_add_u32 s49, s49, s50
    s_and_b32 s50, s48, 15
    s_add_u32 s49, s49, s50
    s_lshl_b32 s50, s3, 6
    s_add_u32 s49, s49, s50
    s_mul_i32 s49, s49, 514
    v_lshrrev_b32 v7, 5, v1
    v_mul_u32_u24 v7, 526336, v7
    v_and_b32 v8, 31, v1
    v_lshl_add_u32 v7, v8, 4, v7
    buffer_load_dwordx4 v[204:207], v7, s[8:11], s49 offen nt
    buffer_load_dwordx4 v[208:211], v7, s[12:15], s49 offen nt
    s_mov_b32 exec_lo, 1
    s_mov_b32 exec_hi, 1
    buffer_load_ushort v220, v7, s[8:11], s49 offen offset:512
    buffer_load_ushort v221, v7, s[12:15], s49 offen offset:512
    s_mov_b64 exec, -1
    s_lshl_b32 s48, s3, 11
    s_add_u32 s48, s48, 139264
    v_add_u32 v229, s48, v228
    v_lshlrev_b32 v230, 8, v3
    v_lshl_add_u32 v230, v2, 3, v230
    v_add_u32 v230, s48, v230
    v_cmp_ne_u32 vcc, 0, v2
    s_nop 1
    v_cndmask_b32 v223, 0, -1, vcc
    v_cndmask_b32 v222, -1, 0, vcc
    v_lshl_add_u32 v9, v3, 7, v2
    v_sub_u32 v10, 512, v9
    v_subrev_u32 v11, 240, v9
    v_cndmask_b32 v10, v11, v10, vcc
    v_mov_b32 v11, 1312
    v_sub_u32 v12, 0, v11
    v_cndmask_b32 v12, v11, v12, vcc
    v_cmp_gt_u32 vcc, 2, v3
    s_lshl_b32 s49, s3, 3
    s_add_u32 s49, s49, 151552
    v_cndmask_b32 v10, v10, v9, vcc
    v_cndmask_b32 v12, v12, v11, vcc
    v_mad_u32_u24 v224, v10, 40, s49
    v_and_b32 v10, 0xf8, v10
    v_add_u32 v224, v224, v10
    v_add_u32 v225, v224, v12
    v_add_u32 v226, v225, v12
    v_add_u32 v227, v226, v12
    s_mov_b32 s48, 0x55555556
    s_mul_i32 s50, s3, 2624
    s_add_u32 s49, s50, 151552
    v_add_u32 v9, 0, v1
    v_mul_hi_u32 v10, v9, s48
    v_mul_u32_u24 v11, 3, v10
    v_sub_u32 v11, v9, v11
    v_mul_u32_u24 v11, 12, v11
    v_mad_u32_u24 v11, v10, 40, v11
    v_and_b32 v10, 0xf8, v10
    v_add3_u32 v247, v11, v10, s49
    v_add_u32 v9, 64, v1
    v_mul_hi_u32 v10, v9, s48
    v_mul_u32_u24 v11, 3, v10
    v_sub_u32 v11, v9, v11
    v_mul_u32_u24 v11, 12, v11
    v_mad_u32_u24 v11, v10, 40, v11
    v_and_b32 v10, 0xf8, v10
    v_add3_u32 v248, v11, v10, s49
    v_add_u32 v9, 128, v1
    v_mul_hi_u32 v10, v9, s48
    v_mul_u32_u24 v11, 3, v10
    v_sub_u32 v11, v9, v11
    v_mul_u32_u24 v11, 12, v11
    v_mad_u32_u24 v11, v10, 40, v11
    v_and_b32 v10, 0xf8, v10
    v_add3_u32 v249, v11, v10, s49
    s_add_u32 s49, s50, 61440
    v_lshrrev_b32 v10, 1, v1
    v_and_b32 v11, 1, v1
    v_lshlrev_b32 v11, 4, v11
    v_mad_u32_u24 v11, v10, 40, v11
    v_and_b32 v10, 0xf8, v10
    v_add3_u32 v250, v11, v10, s49
    v_and_b32 v9, 31, v1
    v_lshrrev_b32 v10, 5, v1
    v_lshlrev_b32 v10, 4, v10
    s_lshl_b32 s49, s3, 2
    s_add_u32 s49, s49, 61440
    v_add_u32 v245, s49, v10
    v_mul_u32_u24 v9, 328, v9
    v_add_u32 v244, v9, v245
    v_lshlrev_b32 v235, 4, v1
    v_lshlrev_b32 v246, 12, v1
    s_lshl_b32 s48, s42, 4
    s_add_u32 s48, s48, s43
    s_mul_i32 s48, s48, 20608
    s_add_u32 s48, s48, 2097152
    s_mul_i32 s49, s3, 3072
    s_add_u32 s48, s48, s49
    v_cvt_f32_u32 v16, v2
    v_cvt_f32_u32 v17, v3
    v_mov_b32 v20, 0xbc003c00
    v_cmp_ne_u32 vcc, 0, v2
    v_mul_f32 v18, 0x3d000000, v16
    v_mul_f32 v19, v18, v17
    v_mul_f32 v19, 0x41000000, v19
    v_cos_f32 v24, v19
    v_sin_f32 v32, v19
    v_add_f32 v19, v19, v18
    v_cos_f32 v25, v19
    v_sin_f32 v33, v19
    v_add_f32 v19, v19, v18
    v_cos_f32 v26, v19
    v_sin_f32 v34, v19
    v_add_f32 v19, v19, v18
    v_cos_f32 v27, v19
    v_sin_f32 v35, v19
    v_add_f32 v19, v19, v18
    v_cos_f32 v28, v19
    v_sin_f32 v36, v19
    v_add_f32 v19, v19, v18
    v_cos_f32 v29, v19
    v_sin_f32 v37, v19
    v_add_f32 v19, v19, v18
    v_cos_f32 v30, v19
    v_sin_f32 v38, v19
    v_add_f32 v19, v19, v18
    v_cos_f32 v31, v19
    v_sin_f32 v39, v19
    v_cvt_pk_f16_f32 v104, v24, v25
    v_cvt_pk_f16_f32 v108, -v32, -v33
    v_cndmask_b32 v108, v20, v108, vcc
    v_cvt_pk_f16_f32 v105, v26, v27
    v_cvt_pk_f16_f32 v109, -v34, -v35
    v_cndmask_b32 v109, v20, v109, vcc
    v_cvt_pk_f16_f32 v106, v28, v29
    v_cvt_pk_f16_f32 v110, -v36, -v37
    v_cndmask_b32 v110, v20, v110, vcc
    v_cvt_pk_f16_f32 v107, v30, v31
    v_cvt_pk_f16_f32 v111, -v38, -v39
    v_cndmask_b32 v111, v20, v111, vcc
    v_mul_f32 v18, 0x3b000000, v16
    v_mul_f32 v19, v18, v17
    v_mul_f32 v19, 4.0, v19
    v_cos_f32 v112, v19
    v_sin_f32 v116, v19
    v_add_f32 v19, v19, v18
    v_cos_f32 v113, v19
    v_sin_f32 v117, v19
    v_add_f32 v19, v19, v18
    v_cos_f32 v114, v19
    v_sin_f32 v118, v19
    v_add_f32 v19, v19, v18
    v_cos_f32 v115, v19
    v_sin_f32 v119, v19
    s_waitcnt vmcnt(8)
    v_lshlrev_b32 v16, 16, v184
    v_lshlrev_b32 v24, 16, v188
    v_and_b32 v17, s39, v184
    v_and_b32 v25, s39, v188
    v_lshlrev_b32 v18, 16, v185
    v_lshlrev_b32 v26, 16, v189
    v_and_b32 v19, s39, v185
    v_and_b32 v27, s39, v189
    v_lshlrev_b32 v20, 16, v186
    v_lshlrev_b32 v28, 16, v190
    v_and_b32 v21, s39, v186
    v_and_b32 v29, s39, v190
    v_lshlrev_b32 v22, 16, v187
    v_lshlrev_b32 v30, 16, v191
    v_and_b32 v23, s39, v187
    v_and_b32 v31, s39, v191
    v_readfirstlane_b32 s50, v16
    v_readfirstlane_b32 s54, v24
    s_nop 0
    v_add_f32 v32, v16, -s50
    v_add_f32 v33, v17, -s50
    v_add_f32 v40, v24, -s54
    v_add_f32 v41, v25, -s54
    v_add_f32 v34, v18, -s50
    v_add_f32 v35, v19, -s50
    v_add_f32 v42, v26, -s54
    v_add_f32 v43, v27, -s54
    v_add_f32 v36, v20, -s50
    v_add_f32 v37, v21, -s50
    v_add_f32 v44, v28, -s54
    v_add_f32 v45, v29, -s54
    v_add_f32 v38, v22, -s50
    v_add_f32 v39, v23, -s50
    v_add_f32 v46, v30, -s54
    v_add_f32 v47, v31, -s54
    v_add_f32 v136, v32, v34
    v_add_f32 v137, v33, v35
    v_add_f32 v144, v40, v42
    v_add_f32 v145, v41, v43
    v_add_f32 v138, v36, v38
    v_add_f32 v139, v37, v39
    v_add_f32 v146, v44, v46
    v_add_f32 v147, v45, v47
    v_mul_f32 v140, v32, v32
    v_mul_f32 v141, v33, v33
    v_mul_f32 v148, v40, v40
    v_mul_f32 v149, v41, v41
    v_mul_f32 v142, v34, v34
    v_mul_f32 v143, v35, v35
    v_mul_f32 v150, v42, v42
    v_mul_f32 v151, v43, v43
    v_add_f32 v136, v136, v138
    v_add_f32 v137, v137, v139
    v_add_f32 v144, v144, v146
    v_add_f32 v145, v145, v147
    v_fma_f32 v140, v36, v36, v140
    v_fma_f32 v141, v37, v37, v141
    v_fma_f32 v148, v44, v44, v148
    v_fma_f32 v149, v45, v45, v149
    v_fma_f32 v142, v38, v38, v142
    v_fma_f32 v143, v39, v39, v143
    v_fma_f32 v150, v46, v46, v150
    v_fma_f32 v151, v47, v47, v151
    v_add_f32 v236, v136, v137
    v_add_f32 v239, v144, v145
    v_add_f32 v140, v140, v142
    v_add_f32 v141, v141, v143
    v_add_f32 v148, v148, v150
    v_add_f32 v149, v149, v151
    v_add_f32 v237, v140, v141
    v_add_f32 v240, v148, v149
    v_add_f32_dpp v236, v236, v236 quad_perm:[1,0,3,2] row_mask:0xf bank_mask:0xf
    v_add_f32_dpp v239, v239, v239 quad_perm:[1,0,3,2] row_mask:0xf bank_mask:0xf
    v_add_f32_dpp v237, v237, v237 quad_perm:[1,0,3,2] row_mask:0xf bank_mask:0xf
    v_add_f32_dpp v240, v240, v240 quad_perm:[1,0,3,2] row_mask:0xf bank_mask:0xf
    v_add_f32_dpp v236, v236, v236 quad_perm:[2,3,0,1] row_mask:0xf bank_mask:0xf
    v_add_f32_dpp v239, v239, v239 quad_perm:[2,3,0,1] row_mask:0xf bank_mask:0xf
    v_add_f32_dpp v237, v237, v237 quad_perm:[2,3,0,1] row_mask:0xf bank_mask:0xf
    v_add_f32_dpp v240, v240, v240 quad_perm:[2,3,0,1] row_mask:0xf bank_mask:0xf
    v_add_f32_dpp v236, v236, v236 row_half_mirror row_mask:0xf bank_mask:0xf
    v_add_f32_dpp v239, v239, v239 row_half_mirror row_mask:0xf bank_mask:0xf
    v_add_f32_dpp v237, v237, v237 row_half_mirror row_mask:0xf bank_mask:0xf
    v_add_f32_dpp v240, v240, v240 row_half_mirror row_mask:0xf bank_mask:0xf
    v_add_f32_dpp v236, v236, v236 row_mirror row_mask:0xf bank_mask:0xf
    v_add_f32_dpp v239, v239, v239 row_mirror row_mask:0xf bank_mask:0xf
    v_add_f32_dpp v237, v237, v237 row_mirror row_mask:0xf bank_mask:0xf
    v_add_f32_dpp v240, v240, v240 row_mirror row_mask:0xf bank_mask:0xf
    v_add_f32_dpp v236, v236, v236 row_bcast:15 row_mask:0xa bank_mask:0xf
    v_add_f32_dpp v239, v239, v239 row_bcast:15 row_mask:0xa bank_mask:0xf
    v_add_f32_dpp v237, v237, v237 row_bcast:15 row_mask:0xa bank_mask:0xf
    v_add_f32_dpp v240, v240, v240 row_bcast:15 row_mask:0xa bank_mask:0xf
    v_add_f32_dpp v236, v236, v236 row_bcast:31 row_mask:0xc bank_mask:0xf
    v_add_f32_dpp v239, v239, v239 row_bcast:31 row_mask:0xc bank_mask:0xf
    v_add_f32_dpp v237, v237, v237 row_bcast:31 row_mask:0xc bank_mask:0xf
    v_add_f32_dpp v240, v240, v240 row_bcast:31 row_mask:0xc bank_mask:0xf
    v_mul_f32 v236, 0x3b000000, v236
    v_mul_f32 v239, 0x3b000000, v239
    v_mul_f32 v237, 0x3b000000, v237
    v_mul_f32 v240, 0x3b000000, v240
    v_fma_f32 v237, -v236, v236, v237
    v_fma_f32 v240, -v239, v239, v240
    v_add_f32 v236, s50, v236
    v_add_f32 v239, s54, v239
    v_max_f32 v237, 0, v237
    v_max_f32 v240, 0, v240
    v_cvt_pk_bf16_f32 v236, v236, v237
    v_cvt_pk_bf16_f32 v239, v239, v240
    v_and_b32 v237, s39, v236
    v_and_b32 v240, s39, v239
    v_lshlrev_b32 v236, 16, v236
    v_lshlrev_b32 v239, 16, v239
    v_add_f32 v237, 0x3727c5ac, v237
    v_add_f32 v240, 0x3727c5ac, v240
    v_readlane_b32 s52, v236, 63
    v_readlane_b32 s56, v239, 63
    v_cvt_pk_bf16_f32 v237, v237, v237
    v_cvt_pk_bf16_f32 v240, v240, v240
    v_lshlrev_b32 v237, 16, v237
    v_lshlrev_b32 v240, 16, v240
    v_sqrt_f32 v237, v237
    v_sqrt_f32 v240, v240
    v_add_f32 v32, v16, -s52
    v_add_f32 v33, v17, -s52
    v_add_f32 v40, v24, -s56
    v_add_f32 v41, v25, -s56
    v_add_f32 v34, v18, -s52
    v_add_f32 v35, v19, -s52
    v_add_f32 v42, v26, -s56
    v_add_f32 v43, v27, -s56
    v_add_f32 v36, v20, -s52
    v_add_f32 v37, v21, -s52
    v_add_f32 v44, v28, -s56
    v_add_f32 v45, v29, -s56
    v_add_f32 v38, v22, -s52
    v_add_f32 v39, v23, -s52
    v_add_f32 v46, v30, -s56
    v_add_f32 v47, v31, -s56
    v_cvt_pk_bf16_f32 v237, v237, v237
    v_cvt_pk_bf16_f32 v240, v240, v240
    v_lshlrev_b32 v237, 16, v237
    v_lshlrev_b32 v240, 16, v240
    v_rcp_f32 v238, v237
    v_rcp_f32 v241, v240
    v_cvt_pk_bf16_f32 v136, v32, v33
    v_cvt_pk_bf16_f32 v144, v40, v41
    v_cvt_pk_bf16_f32 v137, v34, v35
    v_cvt_pk_bf16_f32 v145, v42, v43
    v_cvt_pk_bf16_f32 v138, v36, v37
    v_cvt_pk_bf16_f32 v146, v44, v45
    v_cvt_pk_bf16_f32 v139, v38, v39
    v_cvt_pk_bf16_f32 v147, v46, v47
    v_readlane_b32 s50, v238, 63
    v_readlane_b32 s54, v241, 63
    v_lshlrev_b32 v16, 16, v136
    v_lshlrev_b32 v24, 16, v144
    v_and_b32 v17, s39, v136
    v_and_b32 v25, s39, v144
    v_lshlrev_b32 v18, 16, v137
    v_lshlrev_b32 v26, 16, v145
    v_and_b32 v19, s39, v137
    v_and_b32 v27, s39, v145
    v_lshlrev_b32 v20, 16, v138
    v_lshlrev_b32 v28, 16, v146
    v_and_b32 v21, s39, v138
    v_and_b32 v29, s39, v146
    v_lshlrev_b32 v22, 16, v139
    v_lshlrev_b32 v30, 16, v147
    v_and_b32 v23, s39, v139
    v_and_b32 v31, s39, v147
    v_mul_f32 v32, v16, s50
    v_mul_f32 v33, v17, s50
    v_mul_f32 v40, v24, s54
    v_mul_f32 v41, v25, s54
    v_mul_f32 v34, v18, s50
    v_mul_f32 v35, v19, s50
    v_mul_f32 v42, v26, s54
    v_mul_f32 v43, v27, s54
    v_mul_f32 v36, v20, s50
    v_mul_f32 v37, v21, s50
    v_mul_f32 v44, v28, s54
    v_mul_f32 v45, v29, s54
    v_mul_f32 v38, v22, s50
    v_mul_f32 v39, v23, s50
    v_mul_f32 v46, v30, s54
    v_mul_f32 v47, v31, s54
    v_cvt_pk_bf16_f32 v136, v32, v33
    v_cvt_pk_bf16_f32 v144, v40, v41
    v_cvt_pk_bf16_f32 v137, v34, v35
    v_cvt_pk_bf16_f32 v145, v42, v43
    v_cvt_pk_bf16_f32 v138, v36, v37
    v_cvt_pk_bf16_f32 v146, v44, v45
    v_cvt_pk_bf16_f32 v139, v38, v39
    v_cvt_pk_bf16_f32 v147, v46, v47
    s_waitcnt lgkmcnt(0)
    s_mul_i32 s62, s38, 1664525
    s_add_u32 s62, s62, 1013904223
    s_or_b32 s62, s62, 1
    s_add_u32 s63, s62, 2
    s_cmp_eq_u32 s62, s38
    s_cselect_b32 s38, s63, s62
    v_mov_b32 v7, s38
    ds_write_b32 v6, v7 offset:96
    v_lshlrev_b32 v16, 16, v136
    v_and_b32 v17, s39, v136
    v_lshlrev_b32 v18, 16, v137
    v_and_b32 v19, s39, v137
    v_lshlrev_b32 v20, 16, v138
    v_and_b32 v21, s39, v138
    v_lshlrev_b32 v22, 16, v139
    v_and_b32 v23, s39, v139
    v_cvt_pkrtz_f16_f32 v32, v16, v17
    v_cvt_pkrtz_f16_f32 v33, v18, v19
    v_cvt_pkrtz_f16_f32 v34, v20, v21
    v_cvt_pkrtz_f16_f32 v35, v22, v23
    ds_write_b128 v229, v[32:35] offset:0
    ds_read_b64_tr_b16 v[36:37], v230 offset:0
    ds_read_b64_tr_b16 v[38:39], v230 offset:128
    v_lshlrev_b32 v24, 16, v144
    v_and_b32 v25, s39, v144
    v_lshlrev_b32 v26, 16, v145
    v_and_b32 v27, s39, v145
    v_lshlrev_b32 v28, 16, v146
    v_and_b32 v29, s39, v146
    v_lshlrev_b32 v30, 16, v147
    v_and_b32 v31, s39, v147
    v_cvt_pkrtz_f16_f32 v40, v24, v25
    v_cvt_pkrtz_f16_f32 v41, v26, v27
    v_cvt_pkrtz_f16_f32 v42, v28, v29
    v_cvt_pkrtz_f16_f32 v43, v30, v31
    ds_write_b128 v229, v[40:43] offset:1024
    ds_read_b64_tr_b16 v[44:45], v230 offset:1024
    ds_read_b64_tr_b16 v[46:47], v230 offset:1152
    s_waitcnt vmcnt(4)
    s_waitcnt lgkmcnt(3)
    v_mfma_f32_16x16x32_f16 v[136:139], v[36:39], v[104:107], 0
    v_mfma_f32_16x16x32_f16 v[140:143], v[36:39], v[108:111], 0
    s_waitcnt lgkmcnt(0)
    v_mfma_f32_16x16x32_f16 v[144:147], v[44:47], v[104:107], 0
    v_mfma_f32_16x16x32_f16 v[148:151], v[44:47], v[108:111], 0
    s_mov_b32 s46, 0x05040100
    s_mov_b32 s47, 0x07060302
    s_waitcnt vmcnt(0)
    v_perm_b32 v212, v208, v204, s46
    v_perm_b32 v213, v208, v204, s47
    v_perm_b32 v214, v209, v205, s46
    v_perm_b32 v215, v209, v205, s47
    v_perm_b32 v216, v210, v206, s46
    v_perm_b32 v217, v210, v206, s47
    v_perm_b32 v218, v211, v207, s46
    v_perm_b32 v219, v211, v207, s47
    v_lshl_or_b32 v220, v221, 16, v220
    ds_write_b32 v244, v212 offset:0
    ds_write_b32 v244, v213 offset:40
    ds_write_b32 v244, v214 offset:80
    ds_write_b32 v244, v215 offset:120
    ds_write_b32 v244, v216 offset:160
    ds_write_b32 v244, v217 offset:200
    ds_write_b32 v244, v218 offset:240
    ds_write_b32 v244, v219 offset:280
    s_mov_b32 exec_lo, 1
    s_mov_b32 exec_hi, 1
    ds_write_b32 v245, v220 offset:10496
    s_mov_b64 exec, -1
    s_mov_b64 exec, 1
    ds_add_u32 v6, v5 offset:24
    s_mov_b64 exec, -1
    v_mul_f32 v16, v136, v112
    v_mul_f32 v17, v137, v113
    v_mul_f32 v20, v140, v112
    v_mul_f32 v21, v141, v113
    v_mul_f32 v18, v138, v114
    v_mul_f32 v19, v139, v115
    v_mul_f32 v22, v142, v114
    v_mul_f32 v23, v143, v115
    v_fma_f32 v16, v140, v116, v16
    v_fma_f32 v17, v141, v117, v17
    v_fma_f32 v20, -v136, v116, v20
    v_fma_f32 v21, -v137, v117, v21
    v_fma_f32 v18, v142, v118, v18
    v_fma_f32 v19, v143, v119, v19
    v_fma_f32 v22, -v138, v118, v22
    v_fma_f32 v23, -v139, v119, v23
    v_cvt_pk_f16_f32 v32, v16, v17
    v_cvt_pk_f16_f32 v33, v18, v19
    v_cvt_pk_f16_f32 v34, v20, v21
    v_cvt_pk_f16_f32 v35, v22, v23
    v_and_b32 v136, v32, v223
    v_and_b32 v137, v33, v223
    v_and_b32 v138, v34, v223
    v_and_b32 v139, v35, v223
    v_and_b32 v140, v32, v222
    v_and_b32 v141, v33, v222
    v_and_b32 v142, v34, v222
    v_and_b32 v143, v35, v222
    v_mfma_f32_16x16x32_f16 v[16:19], v[120:123], v[136:139], 0
    v_mfma_f32_16x16x32_f16 v[20:23], v[124:127], v[136:139], 0
    v_mfma_f32_16x16x32_f16 v[16:19], v[128:131], v[140:143], v[16:19]
    v_mfma_f32_16x16x32_f16 v[20:23], v[132:135], v[140:143], v[20:23]
    v_mul_f32 v24, v144, v112
    v_mul_f32 v25, v145, v113
    v_mul_f32 v28, v148, v112
    v_mul_f32 v29, v149, v113
    v_mul_f32 v26, v146, v114
    v_mul_f32 v27, v147, v115
    v_mul_f32 v30, v150, v114
    v_mul_f32 v31, v151, v115
    v_fma_f32 v24, v148, v116, v24
    v_fma_f32 v25, v149, v117, v25
    v_fma_f32 v28, -v144, v116, v28
    v_fma_f32 v29, -v145, v117, v29
    v_fma_f32 v26, v150, v118, v26
    v_fma_f32 v27, v151, v119, v27
    v_fma_f32 v30, -v146, v118, v30
    v_fma_f32 v31, -v147, v119, v31
    v_cvt_pk_f16_f32 v40, v24, v25
    v_cvt_pk_f16_f32 v41, v26, v27
    v_cvt_pk_f16_f32 v42, v28, v29
    v_cvt_pk_f16_f32 v43, v30, v31
    v_and_b32 v144, v40, v223
    v_and_b32 v145, v41, v223
    v_and_b32 v146, v42, v223
    v_and_b32 v147, v43, v223
    v_and_b32 v148, v40, v222
    v_and_b32 v149, v41, v222
    v_and_b32 v150, v42, v222
    v_and_b32 v151, v43, v222
    v_mfma_f32_16x16x32_f16 v[24:27], v[120:123], v[144:147], 0
    v_mfma_f32_16x16x32_f16 v[28:31], v[124:127], v[144:147], 0
    v_mfma_f32_16x16x32_f16 v[24:27], v[128:131], v[148:151], v[24:27]
    v_mfma_f32_16x16x32_f16 v[28:31], v[132:135], v[148:151], v[28:31]
    s_mov_b32 s63, 32768
    s_nop 6
BW_1:
    ds_read_b32 v7, v6 offset:24
    s_waitcnt lgkmcnt(0)
    v_readfirstlane_b32 s62, v7
    s_nop 0
    s_cmp_ge_u32 s62, 4
    s_cbranch_scc1 BD_2
    s_sub_u32 s63, s63, 1
    s_cmp_lg_u32 s63, 0
    s_cbranch_scc1 BW_1
BD_2:
    ds_read2_b64 v[204:207], v250 offset0:0 offset1:1
    ds_read2_b64 v[208:211], v250 offset0:164 offset1:165
    v_add_u32 v7, 71936, v235
    ds_read_b128 v[212:215], v7
    s_lshl_b32 s46, s3, 10
    s_sub_u32 s58, s48, s46
    s_add_u32 s58, s58, 12288
    s_cmp_eq_u32 s3, 0
    s_cselect_b32 s46, 3, 0
    s_mov_b32 s47, 0
    s_waitcnt lgkmcnt(2)
    buffer_store_dwordx4 v[204:207], v235, s[24:27], s58 offen offset:0 sc1
    s_waitcnt lgkmcnt(1)
    buffer_store_dwordx4 v[208:211], v235, s[24:27], s58 offen offset:1024 sc1
    s_waitcnt lgkmcnt(0)
    s_add_u32 s58, s58, 8192
    s_mov_b64 exec, s[46:47]
    buffer_store_dwordx4 v[212:215], v235, s[24:27], s58 offen sc1
    s_mov_b64 exec, -1
    v_mov_b32 v195, s38
    s_lshl_b32 s46, s42, 4
    s_add_u32 s46, s46, s43
    s_lshl_b32 s46, s46, 2
    s_add_u32 s46, s46, s3
    s_lshl_b32 s46, s46, 5
    s_add_u32 s46, s46, 22413312
    v_mov_b32 v192, s52
    v_mov_b32 v194, s50
    v_writelane_b32 v192, s56, 1
    v_writelane_b32 v194, s54, 1
    v_xor_b32 v192, 0x80000000, v192
    v_lshlrev_b32 v7, 4, v1
    s_lshl_b32 s47, s3, 5
    s_add_u32 s47, s47, 147456
    v_add_u32 v7, s47, v7
    s_mov_b32 s60, s46
    s_mov_b64 exec, 3
    ds_write_b128 v7, v[192:195]
    s_mov_b64 exec, -1
    v_cvt_pk_f16_f32 v32, v16, v20
    v_cvt_pk_f16_f32 v33, v17, v21
    v_cvt_pk_f16_f32 v34, v18, v22
    v_cvt_pk_f16_f32 v35, v19, v23
    ds_write_b32 v224, v32 offset:0
    ds_write_b32 v225, v33 offset:0
    ds_write_b32 v226, v34 offset:0
    ds_write_b32 v227, v35 offset:0
    v_cvt_pk_f16_f32 v40, v24, v28
    v_cvt_pk_f16_f32 v41, v25, v29
    v_cvt_pk_f16_f32 v42, v26, v30
    v_cvt_pk_f16_f32 v43, v27, v31
    ds_write_b32 v224, v40 offset:4
    ds_write_b32 v225, v41 offset:4
    ds_write_b32 v226, v42 offset:4
    ds_write_b32 v227, v43 offset:4
    s_mov_b64 exec, 1
    ds_add_u32 v6, v5 offset:0
    s_mov_b64 exec, -1
    s_mov_b32 s63, 32768
BW_3:
    ds_read_b32 v7, v6 offset:0
    s_waitcnt lgkmcnt(0)
    v_readfirstlane_b32 s62, v7
    s_nop 0
    s_cmp_ge_u32 s62, 4
    s_cbranch_scc1 BD_4
    s_sub_u32 s63, s63, 1
    s_cmp_lg_u32 s63, 0
    s_cbranch_scc1 BW_3
BD_4:
    ds_read2_b32 v[196:197], v247 offset0:0 offset1:1
    ds_read_b32 v198, v247 offset:8
    v_mov_b32 v199, s38
    ds_read2_b32 v[200:201], v248 offset0:0 offset1:1
    ds_read_b32 v202, v248 offset:8
    v_mov_b32 v203, s38
    ds_read2_b32 v[204:205], v249 offset0:0 offset1:1
    ds_read_b32 v206, v249 offset:8
    v_mov_b32 v207, s38
    v_add_u32 v7, 147456, v235
    ds_read_b128 v[20:23], v7
    s_mov_b32 s47, 0
    s_waitcnt vmcnt(0)
    s_waitcnt lgkmcnt(5)
    buffer_store_dwordx4 v[196:199], v235, s[24:27], s48 offen offset:0 sc1
    s_waitcnt lgkmcnt(3)
    buffer_store_dwordx4 v[200:203], v235, s[24:27], s48 offen offset:1024 sc1
    s_waitcnt lgkmcnt(1)
    buffer_store_dwordx4 v[204:207], v235, s[24:27], s48 offen offset:2048 sc1
    s_waitcnt lgkmcnt(0)
    s_cmp_eq_u32 s3, 0
    s_cselect_b32 s46, 0xff, 0
    s_mov_b64 exec, s[46:47]
    buffer_store_dwordx4 v[20:23], v235, s[24:27], s60 offen sc1
    s_mov_b64 exec, -1
    s_mov_b64 exec, 1
    ds_add_u32 v6, v5 offset:52
    s_mov_b64 exec, -1
    s_lshl_b32 s60, s36, 5
    s_add_u32 s60, s60, s37
    s_mov_b32 s41, 139264
CFC_START:
    s_lshl_b32 s62, s3, 4
    v_add_u32 v30, s62, v2
    v_lshlrev_b32 v33, 2, v3
    v_add_u32 v35, s62, v33
    v_cvt_f32_u32 v28, v2
    v_cvt_f32_u32 v29, v3
    v_cvt_f32_u32 v30, v30
    v_cvt_f32_u32 v36, v35
    v_mul_f32 v31, 0x3d000000, v28
    v_mul_f32 v32, v31, v29
    v_mul_f32 v32, 4.0, v32
    v_cos_f32 v236, v32
    v_sin_f32 v240, v32
    v_add_f32 v32, v32, v31
    v_cos_f32 v237, v32
    v_sin_f32 v241, v32
    v_add_f32 v32, v32, v31
    v_cos_f32 v238, v32
    v_sin_f32 v242, v32
    v_add_f32 v32, v32, v31
    v_cos_f32 v239, v32
    v_sin_f32 v243, v32
    v_cvt_pk_f16_f32 v104, -v240, -v241
    v_cvt_pk_f16_f32 v106, v236, v237
    v_cvt_pk_f16_f32 v108, v240, v241
    v_cvt_pk_f16_f32 v105, -v242, -v243
    v_cvt_pk_f16_f32 v107, v238, v239
    v_cvt_pk_f16_f32 v109, v242, v243
    v_mul_f32 v236, 0x36000000, v236
    v_mul_f32 v237, 0x36000000, v237
    v_mul_f32 v238, 0x36000000, v238
    v_mul_f32 v239, 0x36000000, v239
    v_mul_f32 v240, 0x36000000, v240
    v_mul_f32 v241, 0x36000000, v241
    v_mul_f32 v242, 0x36000000, v242
    v_mul_f32 v243, 0x36000000, v243
    v_cvt_pk_bf16_f32 v128, v240, v241
    v_cvt_pk_bf16_f32 v130, v236, v237
    v_xor_b32 v132, s40, v128
    v_cvt_pk_bf16_f32 v129, v242, v243
    v_cvt_pk_bf16_f32 v131, v238, v239
    v_xor_b32 v133, s40, v129
    v_mul_f32 v31, 0x3a000000, v28
    v_mul_f32 v32, v31, v36
    v_cos_f32 v168, v32
    v_sin_f32 v176, v32
    v_add_f32 v32, v32, v31
    v_cos_f32 v169, v32
    v_sin_f32 v177, v32
    v_add_f32 v32, v32, v31
    v_cos_f32 v170, v32
    v_sin_f32 v178, v32
    v_add_f32 v32, v32, v31
    v_cos_f32 v171, v32
    v_sin_f32 v179, v32
    v_add_f32 v31, 0x3c000000, v31
    v_mul_f32 v32, v31, v36
    v_cos_f32 v172, v32
    v_sin_f32 v180, v32
    v_add_f32 v32, v32, v31
    v_cos_f32 v173, v32
    v_sin_f32 v181, v32
    v_add_f32 v32, v32, v31
    v_cos_f32 v174, v32
    v_sin_f32 v182, v32
    v_add_f32 v32, v32, v31
    v_cos_f32 v175, v32
    v_sin_f32 v183, v32
    v_mul_f32 v31, 0x3c800000, v30
    v_mul_f32 v32, v31, v29
    v_mul_f32 v32, 4.0, v32
    v_mul_f32 v34, 0x41500000, v31
    v_cos_f32 v236, v32
    v_sin_f32 v240, v32
    v_mul_f32 v33, 0x3d000000, v32
    v_add_f32 v32, v32, v31
    v_cos_f32 v152, v33
    v_sin_f32 v160, v33
    v_cos_f32 v237, v32
    v_sin_f32 v241, v32
    v_mul_f32 v33, 0x3d000000, v32
    v_add_f32 v32, v32, v31
    v_cos_f32 v153, v33
    v_sin_f32 v161, v33
    v_cos_f32 v238, v32
    v_sin_f32 v242, v32
    v_mul_f32 v33, 0x3d000000, v32
    v_add_f32 v32, v32, v31
    v_cos_f32 v154, v33
    v_sin_f32 v162, v33
    v_cos_f32 v239, v32
    v_sin_f32 v243, v32
    v_mul_f32 v33, 0x3d000000, v32
    v_add_f32 v32, v32, v34
    v_cos_f32 v155, v33
    v_sin_f32 v163, v33
    v_cvt_pk_f16_f32 v48, v236, v240
    v_cvt_pk_f16_f32 v52, -v240, v236
    v_cvt_pk_f16_f32 v49, v237, v241
    v_cvt_pk_f16_f32 v53, -v241, v237
    v_cvt_pk_f16_f32 v50, v238, v242
    v_cvt_pk_f16_f32 v54, -v242, v238
    v_cvt_pk_f16_f32 v51, v239, v243
    v_cvt_pk_f16_f32 v55, -v243, v239
    v_cvt_pk_bf16_f32 v80, v240, v241
    v_cvt_pk_bf16_f32 v81, v242, v243
    v_cvt_pk_bf16_f32 v82, v236, v237
    v_cvt_pk_bf16_f32 v83, v238, v239
    v_xor_b32 v84, s40, v80
    v_xor_b32 v85, s40, v81
    v_cos_f32 v236, v32
    v_sin_f32 v240, v32
    v_mul_f32 v33, 0x3d000000, v32
    v_add_f32 v32, v32, v31
    v_cos_f32 v156, v33
    v_sin_f32 v164, v33
    v_cos_f32 v237, v32
    v_sin_f32 v241, v32
    v_mul_f32 v33, 0x3d000000, v32
    v_add_f32 v32, v32, v31
    v_cos_f32 v157, v33
    v_sin_f32 v165, v33
    v_cos_f32 v238, v32
    v_sin_f32 v242, v32
    v_mul_f32 v33, 0x3d000000, v32
    v_add_f32 v32, v32, v31
    v_cos_f32 v158, v33
    v_sin_f32 v166, v33
    v_cos_f32 v239, v32
    v_sin_f32 v243, v32
    v_mul_f32 v33, 0x3d000000, v32
    v_add_f32 v32, v32, v34
    v_cos_f32 v159, v33
    v_sin_f32 v167, v33
    v_cvt_pk_f16_f32 v56, v236, v240
    v_cvt_pk_f16_f32 v60, -v240, v236
    v_cvt_pk_f16_f32 v57, v237, v241
    v_cvt_pk_f16_f32 v61, -v241, v237
    v_cvt_pk_f16_f32 v58, v238, v242
    v_cvt_pk_f16_f32 v62, -v242, v238
    v_cvt_pk_f16_f32 v59, v239, v243
    v_cvt_pk_f16_f32 v63, -v243, v239
    v_cvt_pk_bf16_f32 v86, v240, v241
    v_cvt_pk_bf16_f32 v87, v242, v243
    v_cvt_pk_bf16_f32 v88, v236, v237
    v_cvt_pk_bf16_f32 v89, v238, v239
    v_xor_b32 v90, s40, v86
    v_xor_b32 v91, s40, v87
    v_cos_f32 v236, v32
    v_sin_f32 v240, v32
    v_add_f32 v32, v32, v31
    v_cos_f32 v237, v32
    v_sin_f32 v241, v32
    v_add_f32 v32, v32, v31
    v_cos_f32 v238, v32
    v_sin_f32 v242, v32
    v_add_f32 v32, v32, v31
    v_cos_f32 v239, v32
    v_sin_f32 v243, v32
    v_add_f32 v32, v32, v34
    v_cvt_pk_f16_f32 v64, v236, v240
    v_cvt_pk_f16_f32 v68, -v240, v236
    v_cvt_pk_f16_f32 v65, v237, v241
    v_cvt_pk_f16_f32 v69, -v241, v237
    v_cvt_pk_f16_f32 v66, v238, v242
    v_cvt_pk_f16_f32 v70, -v242, v238
    v_cvt_pk_f16_f32 v67, v239, v243
    v_cvt_pk_f16_f32 v71, -v243, v239
    v_cvt_pk_bf16_f32 v92, v240, v241
    v_cvt_pk_bf16_f32 v93, v242, v243
    v_cvt_pk_bf16_f32 v94, v236, v237
    v_cvt_pk_bf16_f32 v95, v238, v239
    v_xor_b32 v96, s40, v92
    v_xor_b32 v97, s40, v93
    v_cos_f32 v236, v32
    v_sin_f32 v240, v32
    v_add_f32 v32, v32, v31
    v_cos_f32 v237, v32
    v_sin_f32 v241, v32
    v_add_f32 v32, v32, v31
    v_cos_f32 v238, v32
    v_sin_f32 v242, v32
    v_add_f32 v32, v32, v31
    v_cos_f32 v239, v32
    v_sin_f32 v243, v32
    v_cvt_pk_f16_f32 v72, v236, v240
    v_cvt_pk_f16_f32 v76, -v240, v236
    v_cvt_pk_f16_f32 v73, v237, v241
    v_cvt_pk_f16_f32 v77, -v241, v237
    v_cvt_pk_f16_f32 v74, v238, v242
    v_cvt_pk_f16_f32 v78, -v242, v238
    v_cvt_pk_f16_f32 v75, v239, v243
    v_cvt_pk_f16_f32 v79, -v243, v239
    v_cvt_pk_bf16_f32 v98, v240, v241
    v_cvt_pk_bf16_f32 v99, v242, v243
    v_cvt_pk_bf16_f32 v100, v236, v237
    v_cvt_pk_bf16_f32 v101, v238, v239
    v_xor_b32 v102, s40, v98
    v_xor_b32 v103, s40, v99
    s_nop 2
CF_START:
    v_and_b32 v9, 255, v0
    s_mov_b32 s49, 0x55555556
    s_mul_i32 s44, s3, 192
    v_add_u32 v252, s44, v1
    v_add_u32 v34, 0, v252
    v_mul_hi_u32 v35, v34, s49
    v_mul_u32_u24 v36, 3, v35
    v_sub_u32 v36, v34, v36
    v_mul_u32_u24 v34, 20608, v35
    v_lshl_add_u32 v16, v36, 4, v34
    v_mul_u32_u24 v34, 12, v36
    v_lshl_add_u32 v34, v35, 5, v34
    v_add_u32 v19, s41, v34
    v_cmp_gt_u32 vcc, 2, v36
    v_add_u32 v34, 8, v19
    s_nop 0
    v_cndmask_b32 v22, v19, v34, vcc
    v_add_u32 v34, 64, v252
    v_mul_hi_u32 v35, v34, s49
    v_mul_u32_u24 v36, 3, v35
    v_sub_u32 v36, v34, v36
    v_mul_u32_u24 v34, 20608, v35
    v_lshl_add_u32 v17, v36, 4, v34
    v_mul_u32_u24 v34, 12, v36
    v_lshl_add_u32 v34, v35, 5, v34
    v_add_u32 v20, s41, v34
    v_cmp_gt_u32 vcc, 2, v36
    v_add_u32 v34, 8, v20
    s_nop 0
    v_cndmask_b32 v23, v20, v34, vcc
    v_add_u32 v34, 128, v252
    v_mul_hi_u32 v35, v34, s49
    v_mul_u32_u24 v36, 3, v35
    v_sub_u32 v36, v34, v36
    v_mul_u32_u24 v34, 20608, v35
    v_lshl_add_u32 v18, v36, 4, v34
    v_mul_u32_u24 v34, 12, v36
    v_lshl_add_u32 v34, v35, 5, v34
    v_add_u32 v21, s41, v34
    v_cmp_gt_u32 vcc, 2, v36
    v_add_u32 v34, 8, v21
    s_nop 0
    v_cndmask_b32 v24, v21, v34, vcc
    v_mul_u32_u24 v252, 20608, v9
    s_lshl_b32 s45, s60, 5
    s_add_u32 s45, s45, 2109440
    s_and_b32 s44, s60, 255
    s_mul_i32 s44, s44, 48
    s_add_u32 s44, s44, 2097152
    s_mul_i32 s47, s60, 12288
    s_mul_i32 s48, s3, 3072
    s_add_u32 s47, s47, s48
    v_mul_u32_u24 v10, 48, v1
    v_and_b32 v38, 1, v2
    v_mul_u32_u24 v38, 0x8000, v38
    v_lshl_or_b32 v38, v38, 16, v38
    s_brev_b32 s62, 1
    v_xor_b32 v39, s62, v38
    v_xor_b32 v110, v104, v38
    v_xor_b32 v116, s62, v104
    v_xor_b32 v122, v104, v39
    v_xor_b32 v111, v105, v38
    v_xor_b32 v117, s62, v105
    v_xor_b32 v123, v105, v39
    v_xor_b32 v112, v106, v38
    v_xor_b32 v118, s62, v106
    v_xor_b32 v124, v106, v39
    v_xor_b32 v113, v107, v38
    v_xor_b32 v119, s62, v107
    v_xor_b32 v125, v107, v39
    v_xor_b32 v114, v108, v38
    v_xor_b32 v120, s62, v108
    v_xor_b32 v126, v108, v39
    v_xor_b32 v115, v109, v38
    v_xor_b32 v121, s62, v109
    v_xor_b32 v127, v109, v39
    v_xor_b32 v134, v128, v38
    v_xor_b32 v140, s62, v128
    v_xor_b32 v146, v128, v39
    v_xor_b32 v135, v129, v38
    v_xor_b32 v141, s62, v129
    v_xor_b32 v147, v129, v39
    v_xor_b32 v136, v130, v38
    v_xor_b32 v142, s62, v130
    v_xor_b32 v148, v130, v39
    v_xor_b32 v137, v131, v38
    v_xor_b32 v143, s62, v131
    v_xor_b32 v149, v131, v39
    v_xor_b32 v138, v132, v38
    v_xor_b32 v144, s62, v132
    v_xor_b32 v150, v132, v39
    v_xor_b32 v139, v133, v38
    v_xor_b32 v145, s62, v133
    v_xor_b32 v151, v133, v39
    s_add_u32 s62, s41, 12288
    v_lshl_add_u32 v7, v1, 4, s62
    s_lshl_b32 s62, s3, 11
    v_add_u32 v8, s62, v7
    s_add_u32 s62, s41, 0
    v_lshl_add_u32 v9, v1, 5, s62
    s_waitcnt vmcnt(0)
    s_sleep 6
    s_cmp_eq_u32 s61, 0
    s_cbranch_scc1 CF_GO
    s_mov_b32 s63, 32768
BW_5:
    ds_read_b32 v11, v6 offset:20
    s_waitcnt lgkmcnt(0)
    v_readfirstlane_b32 s62, v11
    s_nop 0
    s_cmp_ge_u32 s62, 4
    s_cbranch_scc1 BD_6
    s_sleep 4
    s_sub_u32 s63, s63, 1
    s_cmp_lg_u32 s63, 0
    s_cbranch_scc1 BW_5
BD_6:
    s_sleep 20
CF_GO:
    buffer_load_dwordx4 v[192:195], v16, s[24:27], s44 offen sc1
    buffer_load_dwordx4 v[196:199], v17, s[24:27], s44 offen sc1
    buffer_load_dwordx4 v[200:203], v18, s[24:27], s44 offen sc1
    s_waitcnt vmcnt(0)
    v_cmp_ne_u32 s[84:85], s38, v195
    v_cmp_ne_u32 s[86:87], s38, v199
    v_cmp_ne_u32 s[88:89], s38, v203
    s_or_b64 s[58:59], s[84:85], s[86:87]
    s_or_b64 s[58:59], s[58:59], s[88:89]
    s_cmp_eq_u64 s[58:59], 0
    s_cbranch_scc1 GD_8
    s_mov_b32 s63, 32768
GL_7:
    s_mov_b64 exec, s[84:85]
    buffer_load_dwordx4 v[192:195], v16, s[24:27], s44 offen sc1
    s_mov_b64 exec, s[86:87]
    buffer_load_dwordx4 v[196:199], v17, s[24:27], s44 offen sc1
    s_mov_b64 exec, s[88:89]
    buffer_load_dwordx4 v[200:203], v18, s[24:27], s44 offen sc1
    s_waitcnt vmcnt(0)
    s_mov_b64 exec, s[84:85]
    v_cmp_ne_u32 s[84:85], s38, v195
    s_mov_b64 exec, s[86:87]
    v_cmp_ne_u32 s[86:87], s38, v199
    s_mov_b64 exec, s[88:89]
    v_cmp_ne_u32 s[88:89], s38, v203
    s_mov_b64 exec, -1
    s_or_b64 s[58:59], s[84:85], s[86:87]
    s_or_b64 s[58:59], s[58:59], s[88:89]
    s_cmp_eq_u64 s[58:59], 0
    s_cbranch_scc1 GD_8
    s_sleep 6
    s_sub_u32 s63, s63, 1
    s_cmp_lg_u32 s63, 0
    s_cbranch_scc1 GL_7
GD_8:
    buffer_load_dwordx4 v[244:247], v252, s[24:27], s45 offen offset:0
    buffer_load_dwordx4 v[248:251], v252, s[24:27], s45 offen offset:16
    s_cmp_eq_u32 s61, 1
    s_cbranch_scc1 CF_SC
    s_mov_b32 s63, 32768
BW_9:
    ds_read_b32 v11, v6 offset:52
    s_waitcnt lgkmcnt(0)
    v_readfirstlane_b32 s62, v11
    s_nop 0
    s_cmp_ge_u32 s62, 4
    s_cbranch_scc1 BD_10
    s_sub_u32 s63, s63, 1
    s_cmp_lg_u32 s63, 0
    s_cbranch_scc1 BW_9
BD_10:
CF_SC:
    ds_write_b32 v22, v194
    ds_write2_b32 v19, v192, v193 offset0:0 offset1:1
    ds_write_b32 v23, v198
    ds_write2_b32 v20, v196, v197 offset0:0 offset1:1
    ds_write_b32 v24, v202
    ds_write2_b32 v21, v200, v201 offset0:0 offset1:1
    s_mov_b64 exec, 1
    ds_add_u32 v6, v5 offset:4
    s_mov_b64 exec, -1
    s_mov_b32 s63, 32768
BW_11:
    ds_read_b32 v11, v6 offset:4
    s_waitcnt lgkmcnt(0)
    v_readfirstlane_b32 s62, v11
    s_nop 0
    s_cmp_ge_u32 s62, 4
    s_cbranch_scc1 BD_12
    s_sub_u32 s63, s63, 1
    s_cmp_lg_u32 s63, 0
    s_cbranch_scc1 BW_11
BD_12:
    ds_read_b128 v[16:19], v9 offset:0
    ds_read_b128 v[32:35], v9 offset:16
    ds_read_b128 v[20:23], v9 offset:2048
    ds_read_b128 v[36:39], v9 offset:2064
    ds_read_b128 v[24:27], v9 offset:4096
    ds_read_b128 v[40:43], v9 offset:4112
    ds_read_b128 v[28:31], v9 offset:6144
    ds_read_b128 v[44:47], v9 offset:6160
    s_and_b32 s62, s60, 255
    s_cmp_lg_u32 s62, 0
    s_cbranch_scc1 FFT_NORM
    s_lshr_b32 s62, s60, 4
    s_waitcnt lgkmcnt(0)
    v_bfe_u32 v16, v16, s62, 16
    v_bfe_u32 v17, v17, s62, 16
    v_bfe_u32 v18, v18, s62, 16
    v_bfe_u32 v19, v19, s62, 16
    v_bfe_u32 v20, v20, s62, 16
    v_bfe_u32 v21, v21, s62, 16
    v_bfe_u32 v22, v22, s62, 16
    v_bfe_u32 v23, v23, s62, 16
    v_bfe_u32 v24, v24, s62, 16
    v_bfe_u32 v25, v25, s62, 16
    v_bfe_u32 v26, v26, s62, 16
    v_bfe_u32 v27, v27, s62, 16
    v_bfe_u32 v28, v28, s62, 16
    v_bfe_u32 v29, v29, s62, 16
    v_bfe_u32 v30, v30, s62, 16
    v_bfe_u32 v31, v31, s62, 16
    v_bfe_u32 v32, v32, s62, 16
    v_bfe_u32 v33, v33, s62, 16
    v_bfe_u32 v34, v34, s62, 16
    v_bfe_u32 v35, v35, s62, 16
    v_bfe_u32 v36, v36, s62, 16
    v_bfe_u32 v37, v37, s62, 16
    v_bfe_u32 v38, v38, s62, 16
    v_bfe_u32 v39, v39, s62, 16
    v_bfe_u32 v40, v40, s62, 16
    v_bfe_u32 v41, v41, s62, 16
    v_bfe_u32 v42, v42, s62, 16
    v_bfe_u32 v43, v43, s62, 16
    v_bfe_u32 v44, v44, s62, 16
    v_bfe_u32 v45, v45, s62, 16
    v_bfe_u32 v46, v46, s62, 16
    v_bfe_u32 v47, v47, s62, 16
    s_nop 2
FFT_NORM:
    s_waitcnt lgkmcnt(6)
    v_mfma_f32_16x16x32_f16 v[192:195], v[16:19], v[48:51], 0
    v_mfma_f32_16x16x32_f16 v[200:203], v[16:19], v[52:55], 0
    v_mfma_f32_16x16x32_f16 v[196:199], v[32:35], v[48:51], 0
    v_mfma_f32_16x16x32_f16 v[204:207], v[32:35], v[52:55], 0
    s_waitcnt lgkmcnt(4)
    v_mfma_f32_16x16x32_f16 v[192:195], v[20:23], v[56:59], v[192:195]
    v_mfma_f32_16x16x32_f16 v[200:203], v[20:23], v[60:63], v[200:203]
    v_mfma_f32_16x16x32_f16 v[196:199], v[36:39], v[56:59], v[196:199]
    v_mfma_f32_16x16x32_f16 v[204:207], v[36:39], v[60:63], v[204:207]
    s_waitcnt lgkmcnt(2)
    v_mfma_f32_16x16x32_f16 v[192:195], v[24:27], v[64:67], v[192:195]
    v_mfma_f32_16x16x32_f16 v[200:203], v[24:27], v[68:71], v[200:203]
    v_mfma_f32_16x16x32_f16 v[196:199], v[40:43], v[64:67], v[196:199]
    v_mfma_f32_16x16x32_f16 v[204:207], v[40:43], v[68:71], v[204:207]
    s_waitcnt lgkmcnt(0)
    v_mfma_f32_16x16x32_f16 v[192:195], v[28:31], v[72:75], v[192:195]
    v_mfma_f32_16x16x32_f16 v[200:203], v[28:31], v[76:79], v[200:203]
    v_mfma_f32_16x16x32_f16 v[196:199], v[44:47], v[72:75], v[196:199]
    v_mfma_f32_16x16x32_f16 v[204:207], v[44:47], v[76:79], v[204:207]
    s_nop 4
    v_mul_f32 v208, v192, v152
    v_mul_f32 v209, v193, v153
    v_mul_f32 v216, v200, v152
    v_mul_f32 v217, v201, v153
    v_mul_f32 v210, v194, v154
    v_mul_f32 v211, v195, v155
    v_mul_f32 v218, v202, v154
    v_mul_f32 v219, v203, v155
    v_mul_f32 v212, v196, v156
    v_mul_f32 v213, v197, v157
    v_mul_f32 v220, v204, v156
    v_mul_f32 v221, v205, v157
    v_mul_f32 v214, v198, v158
    v_mul_f32 v215, v199, v159
    v_mul_f32 v222, v206, v158
    v_mul_f32 v223, v207, v159
    v_fma_f32 v208, v200, v160, v208
    v_fma_f32 v209, v201, v161, v209
    v_fma_f32 v216, -v192, v160, v216
    v_fma_f32 v217, -v193, v161, v217
    v_fma_f32 v210, v202, v162, v210
    v_fma_f32 v211, v203, v163, v211
    v_fma_f32 v218, -v194, v162, v218
    v_fma_f32 v219, -v195, v163, v219
    v_fma_f32 v212, v204, v164, v212
    v_fma_f32 v213, v205, v165, v213
    v_fma_f32 v220, -v196, v164, v220
    v_fma_f32 v221, -v197, v165, v221
    v_fma_f32 v214, v206, v166, v214
    v_fma_f32 v215, v207, v167, v215
    v_fma_f32 v222, -v198, v166, v222
    v_fma_f32 v223, -v199, v167, v223
    v_cvt_pk_f16_f32 v224, v208, v209
    v_cvt_pk_f16_f32 v225, v210, v211
    v_cvt_pk_f16_f32 v226, v216, v217
    v_cvt_pk_f16_f32 v227, v218, v219
    v_cvt_pk_f16_f32 v228, v212, v213
    v_cvt_pk_f16_f32 v229, v214, v215
    v_cvt_pk_f16_f32 v230, v220, v221
    v_cvt_pk_f16_f32 v231, v222, v223
    v_mfma_f32_16x16x32_f16 v[192:195], v[106:109], v[224:227], 0
    v_mfma_f32_16x16x32_f16 v[200:203], v[104:107], v[224:227], 0
    v_mfma_f32_16x16x32_f16 v[196:199], v[118:121], v[224:227], 0
    v_mfma_f32_16x16x32_f16 v[204:207], v[116:119], v[224:227], 0
    v_mfma_f32_16x16x32_f16 v[192:195], v[112:115], v[228:231], v[192:195]
    v_mfma_f32_16x16x32_f16 v[200:203], v[110:113], v[228:231], v[200:203]
    v_mfma_f32_16x16x32_f16 v[196:199], v[124:127], v[228:231], v[196:199]
    v_mfma_f32_16x16x32_f16 v[204:207], v[122:125], v[228:231], v[204:207]
    s_waitcnt vmcnt(0)
    v_lshlrev_b32 v236, 16, v244
    v_and_b32 v244, s39, v244
    v_lshlrev_b32 v237, 16, v245
    v_and_b32 v245, s39, v245
    v_lshlrev_b32 v238, 16, v246
    v_and_b32 v246, s39, v246
    v_lshlrev_b32 v239, 16, v247
    v_and_b32 v247, s39, v247
    v_lshlrev_b32 v240, 16, v248
    v_and_b32 v248, s39, v248
    v_lshlrev_b32 v241, 16, v249
    v_and_b32 v249, s39, v249
    v_lshlrev_b32 v242, 16, v250
    v_and_b32 v250, s39, v250
    v_lshlrev_b32 v243, 16, v251
    v_and_b32 v251, s39, v251
    v_mul_f32 v208, v192, v236
    v_mul_f32 v209, v193, v237
    v_mul_f32 v216, v200, v236
    v_mul_f32 v217, v201, v237
    v_mul_f32 v210, v194, v238
    v_mul_f32 v211, v195, v239
    v_mul_f32 v218, v202, v238
    v_mul_f32 v219, v203, v239
    v_mul_f32 v212, v196, v240
    v_mul_f32 v213, v197, v241
    v_mul_f32 v220, v204, v240
    v_mul_f32 v221, v205, v241
    v_mul_f32 v214, v198, v242
    v_mul_f32 v215, v199, v243
    v_mul_f32 v222, v206, v242
    v_mul_f32 v223, v207, v243
    v_fma_f32 v208, -v200, v244, v208
    v_fma_f32 v209, -v201, v245, v209
    v_fma_f32 v216, v192, v244, v216
    v_fma_f32 v217, v193, v245, v217
    v_fma_f32 v210, -v202, v246, v210
    v_fma_f32 v211, -v203, v247, v211
    v_fma_f32 v218, v194, v246, v218
    v_fma_f32 v219, v195, v247, v219
    v_fma_f32 v212, -v204, v248, v212
    v_fma_f32 v213, -v205, v249, v213
    v_fma_f32 v220, v196, v248, v220
    v_fma_f32 v221, v197, v249, v221
    v_fma_f32 v214, -v206, v250, v214
    v_fma_f32 v215, -v207, v251, v215
    v_fma_f32 v222, v198, v250, v222
    v_fma_f32 v223, v199, v251, v223
    v_cvt_pk_bf16_f32 v224, v208, v209
    v_cvt_pk_bf16_f32 v225, v210, v211
    v_cvt_pk_bf16_f32 v226, v216, v217
    v_cvt_pk_bf16_f32 v227, v218, v219
    v_cvt_pk_bf16_f32 v228, v212, v213
    v_cvt_pk_bf16_f32 v229, v214, v215
    v_cvt_pk_bf16_f32 v230, v220, v221
    v_cvt_pk_bf16_f32 v231, v222, v223
    v_mfma_f32_16x16x32_bf16 v[192:195], v[224:227], v[130:133], 0
    v_mfma_f32_16x16x32_bf16 v[200:203], v[224:227], v[128:131], 0
    v_mfma_f32_16x16x32_bf16 v[196:199], v[224:227], v[142:145], 0
    v_mfma_f32_16x16x32_bf16 v[204:207], v[224:227], v[140:143], 0
    v_mfma_f32_16x16x32_bf16 v[192:195], v[228:231], v[136:139], v[192:195]
    v_mfma_f32_16x16x32_bf16 v[200:203], v[228:231], v[134:137], v[200:203]
    v_mfma_f32_16x16x32_bf16 v[196:199], v[228:231], v[148:151], v[196:199]
    v_mfma_f32_16x16x32_bf16 v[204:207], v[228:231], v[146:149], v[204:207]
    s_nop 4
    v_mul_f32 v208, v192, v168
    v_mul_f32 v209, v193, v169
    v_mul_f32 v216, v200, v168
    v_mul_f32 v217, v201, v169
    v_mul_f32 v210, v194, v170
    v_mul_f32 v211, v195, v171
    v_mul_f32 v218, v202, v170
    v_mul_f32 v219, v203, v171
    v_mul_f32 v212, v196, v172
    v_mul_f32 v213, v197, v173
    v_mul_f32 v220, v204, v172
    v_mul_f32 v221, v205, v173
    v_mul_f32 v214, v198, v174
    v_mul_f32 v215, v199, v175
    v_mul_f32 v222, v206, v174
    v_mul_f32 v223, v207, v175
    v_fma_f32 v208, -v200, v176, v208
    v_fma_f32 v209, -v201, v177, v209
    v_fma_f32 v216, v192, v176, v216
    v_fma_f32 v217, v193, v177, v217
    v_fma_f32 v210, -v202, v178, v210
    v_fma_f32 v211, -v203, v179, v211
    v_fma_f32 v218, v194, v178, v218
    v_fma_f32 v219, v195, v179, v219
    v_fma_f32 v212, -v204, v180, v212
    v_fma_f32 v213, -v205, v181, v213
    v_fma_f32 v220, v196, v180, v220
    v_fma_f32 v221, v197, v181, v221
    v_fma_f32 v214, -v206, v182, v214
    v_fma_f32 v215, -v207, v183, v215
    v_fma_f32 v222, v198, v182, v222
    v_fma_f32 v223, v199, v183, v223
    v_cvt_pk_bf16_f32 v224, v208, v209
    v_cvt_pk_bf16_f32 v225, v210, v211
    v_cvt_pk_bf16_f32 v226, v216, v217
    v_cvt_pk_bf16_f32 v227, v218, v219
    v_cvt_pk_bf16_f32 v228, v212, v213
    v_cvt_pk_bf16_f32 v229, v214, v215
    v_cvt_pk_bf16_f32 v230, v220, v221
    v_cvt_pk_bf16_f32 v231, v222, v223
    ds_write_b128 v8, v[224:227]
    ds_write_b128 v8, v[228:231] offset:1024
    s_mov_b64 exec, 1
    ds_add_u32 v6, v5 offset:8
    s_mov_b64 exec, -1
    s_mul_i32 s62, s3, 3072
    s_add_u32 s62, s62, s41
    v_add_u32 v10, s62, v10
    v_lshlrev_b32 v8, 4, v1
    v_add_u32 v9, s62, v8
    s_add_u32 s47, s47, 9437184
    v_mov_b32 v227, s38
    v_mov_b32 v231, s38
    v_mov_b32 v235, s38
    s_mov_b32 s63, 32768
    s_nop 1
BW_13:
    ds_read_b32 v11, v6 offset:8
    s_waitcnt lgkmcnt(0)
    v_readfirstlane_b32 s62, v11
    s_nop 0
    s_cmp_ge_u32 s62, 4
    s_cbranch_scc1 BD_14
    s_sub_u32 s63, s63, 1
    s_cmp_lg_u32 s63, 0
    s_cbranch_scc1 BW_13
BD_14:
    ds_read_b128 v[16:19], v7 offset:0
    ds_read_b128 v[20:23], v7 offset:1024
    ds_read_b128 v[24:27], v7 offset:2048
    ds_read_b128 v[28:31], v7 offset:3072
    ds_read_b128 v[32:35], v7 offset:4096
    ds_read_b128 v[36:39], v7 offset:5120
    ds_read_b128 v[40:43], v7 offset:6144
    ds_read_b128 v[44:47], v7 offset:7168
    s_waitcnt lgkmcnt(6)
    v_mfma_f32_16x16x32_bf16 v[192:195], v[82:85], v[16:19], 0
    v_mfma_f32_16x16x32_bf16 v[200:203], v[80:83], v[16:19], 0
    v_mfma_f32_16x16x32_bf16 v[196:199], v[82:85], v[20:23], 0
    v_mfma_f32_16x16x32_bf16 v[204:207], v[80:83], v[20:23], 0
    s_waitcnt lgkmcnt(4)
    v_mfma_f32_16x16x32_bf16 v[192:195], v[88:91], v[24:27], v[192:195]
    v_mfma_f32_16x16x32_bf16 v[200:203], v[86:89], v[24:27], v[200:203]
    v_mfma_f32_16x16x32_bf16 v[196:199], v[88:91], v[28:31], v[196:199]
    v_mfma_f32_16x16x32_bf16 v[204:207], v[86:89], v[28:31], v[204:207]
    s_waitcnt lgkmcnt(2)
    v_mfma_f32_16x16x32_bf16 v[192:195], v[94:97], v[32:35], v[192:195]
    v_mfma_f32_16x16x32_bf16 v[200:203], v[92:95], v[32:35], v[200:203]
    v_mfma_f32_16x16x32_bf16 v[196:199], v[94:97], v[36:39], v[196:199]
    v_mfma_f32_16x16x32_bf16 v[204:207], v[92:95], v[36:39], v[204:207]
    s_waitcnt lgkmcnt(0)
    v_mfma_f32_16x16x32_bf16 v[192:195], v[100:103], v[40:43], v[192:195]
    v_mfma_f32_16x16x32_bf16 v[200:203], v[98:101], v[40:43], v[200:203]
    v_mfma_f32_16x16x32_bf16 v[196:199], v[100:103], v[44:47], v[196:199]
    v_mfma_f32_16x16x32_bf16 v[204:207], v[98:101], v[44:47], v[204:207]
    s_mov_b64 exec, 1
    ds_add_u32 v6, v5 offset:12
    s_mov_b64 exec, -1
    s_nop 1
    v_cvt_pk_bf16_f32 v224, v192, v193
    v_cvt_pk_bf16_f32 v225, v194, v195
    v_cvt_pk_bf16_f32 v226, v196, v197
    ds_write_b128 v10, v[224:227] offset:0
    v_cvt_pk_bf16_f32 v228, v198, v199
    v_cvt_pk_bf16_f32 v229, v200, v201
    v_cvt_pk_bf16_f32 v230, v202, v203
    ds_write_b128 v10, v[228:231] offset:16
    v_cvt_pk_bf16_f32 v232, v204, v205
    v_cvt_pk_bf16_f32 v233, v206, v207
    ds_write_b128 v10, v[232:235] offset:32
    ds_read_b128 v[208:211], v9 offset:0
    ds_read_b128 v[212:215], v9 offset:1024
    ds_read_b128 v[216:219], v9 offset:2048
    s_waitcnt lgkmcnt(2)
    buffer_store_dwordx4 v[208:211], v8, s[24:27], s47 offen offset:0 sc1
    s_waitcnt lgkmcnt(1)
    buffer_store_dwordx4 v[212:215], v8, s[24:27], s47 offen offset:1024 sc1
    s_waitcnt lgkmcnt(0)
    buffer_store_dwordx4 v[216:219], v8, s[24:27], s47 offen offset:2048 sc1
    s_cmp_eq_u32 s61, 1
    s_cbranch_scc1 G_CFRET
    s_mov_b32 s49, 0x55555556
    s_mov_b32 s44, 151552
    v_add_u32 v152, 0, v0
    v_mul_hi_u32 v153, v152, s49
    v_mul_u32_u24 v154, 3, v153
    v_sub_u32 v154, v152, v154
    v_mul_u32_u24 v152, 12288, v153
    v_lshl_add_u32 v140, v154, 4, v152
    v_mul_u32_u24 v152, 12, v154
    v_lshl_add_u32 v152, v153, 5, v152
    v_add_u32 v144, s44, v152
    v_cmp_gt_u32 vcc, 2, v154
    v_add_u32 v152, 8, v144
    s_nop 0
    v_cndmask_b32 v148, v144, v152, vcc
    v_add_u32 v152, 256, v0
    v_mul_hi_u32 v153, v152, s49
    v_mul_u32_u24 v154, 3, v153
    v_sub_u32 v154, v152, v154
    v_mul_u32_u24 v152, 12288, v153
    v_lshl_add_u32 v141, v154, 4, v152
    v_mul_u32_u24 v152, 12, v154
    v_lshl_add_u32 v152, v153, 5, v152
    v_add_u32 v145, s44, v152
    v_cmp_gt_u32 vcc, 2, v154
    v_add_u32 v152, 8, v145
    s_nop 0
    v_cndmask_b32 v149, v145, v152, vcc
    v_add_u32 v152, 512, v0
    v_mul_hi_u32 v153, v152, s49
    v_mul_u32_u24 v154, 3, v153
    v_sub_u32 v154, v152, v154
    v_mul_u32_u24 v152, 12288, v153
    v_lshl_add_u32 v142, v154, 4, v152
    v_mul_u32_u24 v152, 12, v154
    v_lshl_add_u32 v152, v153, 5, v152
    v_add_u32 v146, s44, v152
    v_cmp_gt_u32 vcc, 2, v154
    v_add_u32 v152, 8, v146
    s_nop 0
    v_cndmask_b32 v150, v146, v152, vcc
    v_lshlrev_b32 v143, 4, v1
    v_add_u32 v143, 3145728, v143
    v_mul_u32_u24 v147, 12, v1
    v_add_u32 v147, 151568, v147
    s_lshl_b32 s44, s42, 4
    s_add_u32 s44, s44, s43
    s_mul_i32 s44, s44, 48
    s_add_u32 s44, s44, 9437184
    s_cmp_eq_u32 s3, 0
    s_cselect_b32 s48, 3, 0
    s_mov_b32 s49, 0
    v_lshrrev_b32 v7, 2, v2
    v_and_b32 v8, 3, v2
    v_lshl_add_u32 v7, v3, 2, v7
    v_lshl_add_u32 v9, v7, 5, v8
    v_sub_u32 v10, 512, v9
    v_cmp_gt_u32 vcc, 2, v3
    s_nop 1
    v_cndmask_b32 v10, v10, v9, vcc
    v_mov_b32 v11, 128
    v_sub_u32 v12, 0, v11
    v_cndmask_b32 v11, v12, v11, vcc
    s_lshr_b32 s45, s3, 1
    s_lshl_b32 s45, s45, 3
    s_add_u32 s45, s45, 151552
    v_lshl_add_u32 v120, v10, 5, s45
    v_add_u32 v121, v120, v11
    v_add_u32 v122, v121, v11
    v_add_u32 v123, v122, v11
    v_subrev_u32 v9, 240, v9
    v_lshl_add_u32 v9, v9, 5, s45
    v_lshrrev_b32 v12, 1, v3
    v_sub_u32 v12, v8, v12
    v_cmp_eq_u32 vcc, -1, v12
    s_nop 1
    v_cndmask_b32 v120, v120, v9, vcc
    v_cmp_gt_u32 vcc, 4, v2
    s_nop 1
    v_cndmask_b32 v7, 0, -1, vcc
    v_cndmask_b32 v8, -1, 0, vcc
    v_and_b32 v157, 1, v3
    v_lshlrev_b32 v157, 3, v157
    v_lshrrev_b32 v158, 1, v2
    v_add_u32 v157, v157, v158
    v_and_b32 v158, 2, v3
    v_and_b32 v159, 1, v2
    v_add_u32 v158, v158, v159
    v_lshl_add_u32 v157, v157, 2, v158
    s_lshl_b32 s45, s3, 1
    v_bfe_u32 v158, v157, 1, 3
    v_xor_b32 v158, s45, v158
    v_and_b32 v159, 1, v157
    v_lshrrev_b32 v157, 1, v157
    v_lshlrev_b32 v157, 8, v157
    v_lshl_add_u32 v157, v159, 4, v157
    v_add_u32 v157, 139264, v157
    v_lshl_add_u32 v176, v158, 5, v157
    v_xor_b32 v177, 32, v176
    s_mov_b32 s47, 0x2aaaaaab
    s_mul_i32 s45, s3, 24
    v_lshrrev_b32 v157, 3, v1
    v_add_u32 v157, s45, v157
    v_and_b32 v178, 7, v1
    v_lshlrev_b32 v156, 8, v157
    v_lshl_add_u32 v156, v178, 4, v156
    v_mul_hi_u32 v196, v157, s47
    v_mul_u32_u24 v197, 6, v196
    v_sub_u32 v197, v157, v197
    v_and_b32 v198, 1, v197
    v_lshl_add_u32 v196, v196, 1, v198
    v_lshrrev_b32 v197, 1, v197
    v_mul_u32_u24 v197, 12, v197
    v_and_b32 v198, 7, v196
    v_xor_b32 v198, v198, v178
    v_lshl_add_u32 v197, v198, 5, v197
    v_lshl_add_u32 v197, v196, 8, v197
    v_add_u32 v192, 139264, v197
    v_add_u32 v157, 8, v157
    v_mul_hi_u32 v196, v157, s47
    v_mul_u32_u24 v197, 6, v196
    v_sub_u32 v197, v157, v197
    v_and_b32 v198, 1, v197
    v_lshl_add_u32 v196, v196, 1, v198
    v_lshrrev_b32 v197, 1, v197
    v_mul_u32_u24 v197, 12, v197
    v_and_b32 v198, 7, v196
    v_xor_b32 v198, v198, v178
    v_lshl_add_u32 v197, v198, 5, v197
    v_lshl_add_u32 v197, v196, 8, v197
    v_add_u32 v193, 139264, v197
    v_add_u32 v157, 8, v157
    v_mul_hi_u32 v196, v157, s47
    v_mul_u32_u24 v197, 6, v196
    v_sub_u32 v197, v157, v197
    v_and_b32 v198, 1, v197
    v_lshl_add_u32 v196, v196, 1, v198
    v_lshrrev_b32 v197, 1, v197
    v_mul_u32_u24 v197, 12, v197
    v_and_b32 v198, 7, v196
    v_xor_b32 v198, v198, v178
    v_lshl_add_u32 v197, v198, 5, v197
    v_lshl_add_u32 v197, v196, 8, v197
    v_add_u32 v194, 139264, v197
    v_mov_b32 v199, s38
    v_mov_b32 v203, s38
    v_mov_b32 v207, s38
    s_lshl_b32 s46, s42, 3
    s_lshr_b32 s47, s43, 1
    s_add_u32 s47, s46, s47
    s_mul_i32 s46, s47, 24576
    s_and_b32 s45, s43, 1
    s_lshl_b32 s45, s45, 7
    s_add_u32 s46, s46, s45
    s_add_u32 s46, s46, 24117248
    s_add_u32 s47, s46, 4096
    v_cvt_f32_u32 v64, v2
    v_cvt_f32_u32 v65, v3
    v_cmp_gt_u32 vcc, 2, v3
    s_nop 1
    v_cndmask_b32 v68, 0, -1, vcc
    v_and_b32 v70, s40, v68
    v_xor_b32 v69, s40, v70
    v_mul_f32 v80, 0xbef00000, v64
    v_cndmask_b32 v80, v80, 0, vcc
    v_lshlrev_b32 v71, 31, v2
    v_mul_f32 v66, 0x3d800000, v64
    v_mul_f32 v67, v66, v65
    v_mul_f32 v67, 4.0, v67
    v_add_f32 v80, v80, v67
    v_cos_f32 v72, v67
    v_sin_f32 v76, v67
    v_add_f32 v67, v67, v66
    v_cos_f32 v73, v67
    v_sin_f32 v77, v67
    v_add_f32 v67, v67, v66
    v_cos_f32 v74, v67
    v_sin_f32 v78, v67
    v_add_f32 v67, v67, v66
    v_cos_f32 v75, v67
    v_sin_f32 v79, v67
    v_cvt_pk_bf16_f32 v32, v72, v73
    v_cvt_pk_bf16_f32 v36, v76, v77
    v_xor_b32 v34, v36, v70
    v_xor_b32 v38, v32, v69
    v_cvt_pk_bf16_f32 v33, v74, v75
    v_cvt_pk_bf16_f32 v37, v78, v79
    v_xor_b32 v35, v37, v70
    v_xor_b32 v39, v33, v69
    v_cos_f32 v72, v80
    v_sin_f32 v76, v80
    v_add_f32 v80, v80, v66
    v_cos_f32 v73, v80
    v_sin_f32 v77, v80
    v_add_f32 v80, v80, v66
    v_cos_f32 v74, v80
    v_sin_f32 v78, v80
    v_add_f32 v80, v80, v66
    v_cos_f32 v75, v80
    v_sin_f32 v79, v80
    v_cmp_eq_u32 vcc, 0, v3
    v_xor_b32 v67, 0xbf000000, v71
    s_nop 0
    v_cndmask_b32 v72, v72, 0.5, vcc
    v_cndmask_b32 v76, v76, v67, vcc
    v_cvt_pk_bf16_f32 v44, v72, v73
    v_cvt_pk_bf16_f32 v46, -v76, -v77
    v_cvt_pk_bf16_f32 v45, v74, v75
    v_cvt_pk_bf16_f32 v47, -v78, -v79
    v_and_b32 v40, v44, v68
    v_xor_b32 v44, v44, v40
    v_and_b32 v41, v45, v68
    v_xor_b32 v45, v45, v41
    v_and_b32 v42, v46, v68
    v_xor_b32 v46, v46, v42
    v_and_b32 v43, v47, v68
    v_xor_b32 v47, v47, v43
    v_xor_b32 v71, 0xbf800000, v71
    v_mul_f32 v66, 0x3d000000, v64
    v_mul_f32 v67, v66, v65
    v_mul_f32 v66, 4.0, v66
    v_cos_f32 v72, v67
    v_sin_f32 v76, v67
    v_add_f32 v67, v67, v66
    v_cos_f32 v73, v67
    v_sin_f32 v77, v67
    v_add_f32 v67, v67, v66
    v_cos_f32 v74, v67
    v_sin_f32 v78, v67
    v_add_f32 v67, v67, v66
    v_cos_f32 v75, v67
    v_sin_f32 v79, v67
    v_cndmask_b32 v76, v76, v71, vcc
    v_cvt_pk_bf16_f32 v56, v72, v73
    v_cvt_pk_bf16_f32 v58, -v76, -v77
    v_cvt_pk_bf16_f32 v57, v74, v75
    v_cvt_pk_bf16_f32 v59, -v78, -v79
    v_mul_f32 v66, 0x3d000000, v64
    v_add_f32 v66, 0.5, v66
    v_mul_f32 v67, v66, v65
    v_mul_f32 v66, 4.0, v66
    v_cos_f32 v72, v67
    v_sin_f32 v76, v67
    v_add_f32 v67, v67, v66
    v_cos_f32 v73, v67
    v_sin_f32 v77, v67
    v_add_f32 v67, v67, v66
    v_cos_f32 v74, v67
    v_sin_f32 v78, v67
    v_add_f32 v67, v67, v66
    v_cos_f32 v75, v67
    v_sin_f32 v79, v67
    v_cndmask_b32 v76, v76, v71, vcc
    v_cvt_pk_bf16_f32 v60, v72, v73
    v_cvt_pk_bf16_f32 v62, -v76, -v77
    v_cvt_pk_bf16_f32 v61, v74, v75
    v_cvt_pk_bf16_f32 v63, -v78, -v79
    v_mul_f32 v66, 0x3b000000, v64
    v_mul_f32 v67, v66, v65
    v_mul_f32 v66, 4.0, v66
    v_cos_f32 v160, v67
    v_sin_f32 v168, v67
    v_add_f32 v67, v67, v66
    v_cos_f32 v162, v67
    v_sin_f32 v170, v67
    v_add_f32 v67, v67, v66
    v_cos_f32 v164, v67
    v_sin_f32 v172, v67
    v_add_f32 v67, v67, v66
    v_cos_f32 v166, v67
    v_sin_f32 v174, v67
    v_mov_b32 v161, v160
    v_mov_b32 v169, v168
    v_mov_b32 v163, v162
    v_mov_b32 v171, v170
    v_mov_b32 v165, v164
    v_mov_b32 v173, v172
    v_mov_b32 v167, v166
    v_mov_b32 v175, v174
    s_mov_b32 s63, 32768
    s_nop 1
BW_15:
    ds_read_b32 v157, v6 offset:12
    s_waitcnt lgkmcnt(0)
    v_readfirstlane_b32 s62, v157
    s_nop 0
    s_cmp_ge_u32 s62, 4
    s_cbranch_scc1 BD_16
    s_sub_u32 s63, s63, 1
    s_cmp_lg_u32 s63, 0
    s_cbranch_scc1 BW_15
BD_16:
    s_waitcnt vmcnt(0)
    s_sleep 20
    buffer_load_dwordx4 v[124:127], v140, s[24:27], s44 offen sc1
    buffer_load_dwordx4 v[128:131], v141, s[24:27], s44 offen sc1
    buffer_load_dwordx4 v[132:135], v142, s[24:27], s44 offen sc1
    s_mov_b64 exec, s[48:49]
    buffer_load_dwordx4 v[136:139], v143, s[24:27], s44 offen sc1
    s_mov_b64 exec, -1
    s_waitcnt vmcnt(0)
    v_cmp_ne_u32 s[50:51], s38, v127
    v_cmp_ne_u32 s[52:53], s38, v131
    v_cmp_ne_u32 s[54:55], s38, v135
    s_mov_b64 exec, s[48:49]
    v_cmp_ne_u32 s[56:57], s38, v139
    s_mov_b64 exec, -1
    s_or_b64 s[58:59], s[50:51], s[52:53]
    s_or_b64 s[58:59], s[58:59], s[54:55]
    s_or_b64 s[58:59], s[58:59], s[56:57]
    s_cmp_eq_u64 s[58:59], 0
    s_cbranch_scc1 GD_18
    s_mov_b32 s63, 32768
GL_17:
    s_mov_b64 exec, s[50:51]
    buffer_load_dwordx4 v[124:127], v140, s[24:27], s44 offen sc1
    s_mov_b64 exec, s[52:53]
    buffer_load_dwordx4 v[128:131], v141, s[24:27], s44 offen sc1
    s_mov_b64 exec, s[54:55]
    buffer_load_dwordx4 v[132:135], v142, s[24:27], s44 offen sc1
    s_mov_b64 exec, s[56:57]
    buffer_load_dwordx4 v[136:139], v143, s[24:27], s44 offen sc1
    s_waitcnt vmcnt(0)
    s_mov_b64 exec, s[50:51]
    v_cmp_ne_u32 s[50:51], s38, v127
    s_mov_b64 exec, s[52:53]
    v_cmp_ne_u32 s[52:53], s38, v131
    s_mov_b64 exec, s[54:55]
    v_cmp_ne_u32 s[54:55], s38, v135
    s_mov_b64 exec, s[56:57]
    v_cmp_ne_u32 s[56:57], s38, v139
    s_mov_b64 exec, -1
    s_or_b64 s[58:59], s[50:51], s[52:53]
    s_or_b64 s[58:59], s[58:59], s[54:55]
    s_or_b64 s[58:59], s[58:59], s[56:57]
    s_cmp_eq_u64 s[58:59], 0
    s_cbranch_scc1 GD_18
    s_sleep 6
    s_sub_u32 s63, s63, 1
    s_cmp_lg_u32 s63, 0
    s_cbranch_scc1 GL_17
GD_18:
    ds_write_b32 v148, v126
    ds_write2_b32 v144, v124, v125 offset0:0 offset1:1
    ds_write_b32 v149, v130
    ds_write2_b32 v145, v128, v129 offset0:0 offset1:1
    ds_write_b32 v150, v134
    ds_write2_b32 v146, v132, v133 offset0:0 offset1:1
    s_mov_b64 exec, s[48:49]
    ds_write_b32 v147, v136
    s_and_b32 s48, s48, 1
    s_mov_b64 exec, s[48:49]
    ds_write2_b32 v147, v137, v138 offset0:1 offset1:2
    s_mov_b64 exec, -1
    s_mov_b64 exec, 1
    ds_add_u32 v6, v5 offset:16
    s_mov_b64 exec, -1
    s_mov_b32 s63, 32768
BW_19:
    ds_read_b32 v157, v6 offset:16
    s_waitcnt lgkmcnt(0)
    v_readfirstlane_b32 s62, v157
    s_nop 0
    s_cmp_ge_u32 s62, 4
    s_cbranch_scc1 BD_20
    s_sub_u32 s63, s63, 1
    s_cmp_lg_u32 s63, 0
    s_cbranch_scc1 BW_19
BD_20:
    ds_read_b64_tr_b16 v[16:17], v120
    ds_read_b64_tr_b16 v[18:19], v120 offset:16
    ds_read_b64_tr_b16 v[20:21], v121
    ds_read_b64_tr_b16 v[22:23], v121 offset:16
    ds_read_b64_tr_b16 v[24:25], v122
    ds_read_b64_tr_b16 v[26:27], v122 offset:16
    ds_read_b64_tr_b16 v[28:29], v123
    ds_read_b64_tr_b16 v[30:31], v123 offset:16
    s_waitcnt lgkmcnt(6)
    v_and_b32 v112, v16, v8
    v_and_b32 v116, v16, v7
    v_and_b32 v113, v17, v8
    v_and_b32 v117, v17, v7
    v_and_b32 v114, v18, v8
    v_and_b32 v118, v18, v7
    v_and_b32 v115, v19, v8
    v_and_b32 v119, v19, v7
    s_waitcnt lgkmcnt(4)
    v_mfma_f32_16x16x32_bf16 v[68:71], v[20:23], v[32:35], 0
    v_mfma_f32_16x16x32_bf16 v[84:87], v[20:23], v[36:39], 0
    s_waitcnt lgkmcnt(2)
    v_mfma_f32_16x16x32_bf16 v[72:75], v[24:27], v[32:35], 0
    v_mfma_f32_16x16x32_bf16 v[88:91], v[24:27], v[36:39], 0
    s_waitcnt lgkmcnt(0)
    v_mfma_f32_16x16x32_bf16 v[76:79], v[28:31], v[32:35], 0
    v_mfma_f32_16x16x32_bf16 v[92:95], v[28:31], v[36:39], 0
    v_mfma_f32_16x16x32_bf16 v[64:67], v[112:115], v[32:35], 0
    v_mfma_f32_16x16x32_bf16 v[80:83], v[112:115], v[36:39], 0
    v_mfma_f32_16x16x32_bf16 v[64:67], v[116:119], v[40:43], v[64:67]
    v_mfma_f32_16x16x32_bf16 v[80:83], v[116:119], v[44:47], v[80:83]
    s_bitcmp1_b32 s3, 0
    s_cbranch_scc1 RI_H1
    v_mul_f32 v126, v68, v162
    v_mul_f32 v127, v69, v163
    v_mul_f32 v134, v84, v162
    v_mul_f32 v135, v85, v163
    v_mul_f32 v128, v72, v164
    v_mul_f32 v129, v73, v165
    v_mul_f32 v136, v88, v164
    v_mul_f32 v137, v89, v165
    v_fma_f32 v126, -v84, v170, v126
    v_fma_f32 v127, -v85, v171, v127
    v_fma_f32 v134, v68, v170, v134
    v_fma_f32 v135, v69, v171, v135
    v_fma_f32 v128, -v88, v172, v128
    v_fma_f32 v129, -v89, v173, v129
    v_fma_f32 v136, v72, v172, v136
    v_fma_f32 v137, v73, v173, v137
    v_mul_f32 v130, v76, v166
    v_mul_f32 v131, v77, v167
    v_mul_f32 v138, v92, v166
    v_mul_f32 v139, v93, v167
    v_mul_f32 v124, v64, v160
    v_mul_f32 v125, v65, v161
    v_mul_f32 v132, v80, v160
    v_mul_f32 v133, v81, v161
    v_fma_f32 v130, -v92, v174, v130
    v_fma_f32 v131, -v93, v175, v131
    v_fma_f32 v138, v76, v174, v138
    v_fma_f32 v139, v77, v175, v139
    v_fma_f32 v124, -v80, v168, v124
    v_fma_f32 v125, -v81, v169, v125
    v_fma_f32 v132, v64, v168, v132
    v_fma_f32 v133, v65, v169, v133
    s_branch RI_HD
    s_nop 1
RI_H1:
    v_mul_f32 v126, v70, v162
    v_mul_f32 v127, v71, v163
    v_mul_f32 v134, v86, v162
    v_mul_f32 v135, v87, v163
    v_mul_f32 v128, v74, v164
    v_mul_f32 v129, v75, v165
    v_mul_f32 v136, v90, v164
    v_mul_f32 v137, v91, v165
    v_fma_f32 v126, -v86, v170, v126
    v_fma_f32 v127, -v87, v171, v127
    v_fma_f32 v134, v70, v170, v134
    v_fma_f32 v135, v71, v171, v135
    v_fma_f32 v128, -v90, v172, v128
    v_fma_f32 v129, -v91, v173, v129
    v_fma_f32 v136, v74, v172, v136
    v_fma_f32 v137, v75, v173, v137
    v_mul_f32 v130, v78, v166
    v_mul_f32 v131, v79, v167
    v_mul_f32 v138, v94, v166
    v_mul_f32 v139, v95, v167
    v_mul_f32 v124, v66, v160
    v_mul_f32 v125, v67, v161
    v_mul_f32 v132, v82, v160
    v_mul_f32 v133, v83, v161
    v_fma_f32 v130, -v94, v174, v130
    v_fma_f32 v131, -v95, v175, v131
    v_fma_f32 v138, v78, v174, v138
    v_fma_f32 v139, v79, v175, v139
    v_fma_f32 v124, -v82, v168, v124
    v_fma_f32 v125, -v83, v169, v125
    v_fma_f32 v132, v66, v168, v132
    v_fma_f32 v133, v67, v169, v133
    s_nop 2
RI_HD:
    v_cvt_pk_bf16_f32 v16, v124, v126
    v_cvt_pk_bf16_f32 v17, v128, v130
    v_cvt_pk_bf16_f32 v18, v132, v134
    v_cvt_pk_bf16_f32 v19, v136, v138
    v_cvt_pk_bf16_f32 v20, v125, v127
    v_cvt_pk_bf16_f32 v21, v129, v131
    v_cvt_pk_bf16_f32 v22, v133, v135
    v_cvt_pk_bf16_f32 v23, v137, v139
    v_mfma_f32_16x16x32_bf16 v[64:67], v[16:19], v[56:59], 0
    v_mfma_f32_16x16x32_bf16 v[68:71], v[16:19], v[60:63], 0
    v_mfma_f32_16x16x32_bf16 v[72:75], v[20:23], v[56:59], 0
    v_mfma_f32_16x16x32_bf16 v[76:79], v[20:23], v[60:63], 0
    v_lshlrev_b32 v104, 16, v184
    v_and_b32 v105, s39, v184
    v_lshlrev_b32 v106, 16, v185
    v_and_b32 v107, s39, v185
    v_lshlrev_b32 v108, 16, v186
    v_and_b32 v109, s39, v186
    v_lshlrev_b32 v110, 16, v187
    v_and_b32 v111, s39, v187
    v_lshlrev_b32 v40, 16, v188
    v_and_b32 v41, s39, v188
    v_lshlrev_b32 v42, 16, v189
    v_and_b32 v43, s39, v189
    v_lshlrev_b32 v44, 16, v190
    v_and_b32 v45, s39, v190
    v_lshlrev_b32 v46, 16, v191
    v_and_b32 v47, s39, v191
    v_cvt_pk_bf16_f32 v112, v64, v65
    v_cvt_pk_bf16_f32 v113, v66, v67
    v_cvt_pk_bf16_f32 v114, v68, v69
    v_cvt_pk_bf16_f32 v115, v70, v71
    s_nop 0
    v_permlane16_swap_b32 v112, v114
    v_permlane16_swap_b32 v113, v115
    v_lshlrev_b32 v96, 16, v112
    v_and_b32 v97, s39, v112
    v_lshlrev_b32 v98, 16, v113
    v_and_b32 v99, s39, v113
    v_lshlrev_b32 v100, 16, v114
    v_and_b32 v101, s39, v114
    v_lshlrev_b32 v102, 16, v115
    v_and_b32 v103, s39, v115
    v_add_f32 v96, v96, v104
    v_add_f32 v97, v97, v105
    v_add_f32 v98, v98, v106
    v_add_f32 v99, v99, v107
    v_add_f32 v100, v100, v108
    v_add_f32 v101, v101, v109
    v_add_f32 v102, v102, v110
    v_add_f32 v103, v103, v111
    v_cvt_pk_bf16_f32 v184, v96, v97
    v_cvt_pk_bf16_f32 v185, v98, v99
    v_cvt_pk_bf16_f32 v186, v100, v101
    v_cvt_pk_bf16_f32 v187, v102, v103
    ds_write_b128 v176, v[184:187]
    v_cvt_pk_bf16_f32 v116, v72, v73
    v_cvt_pk_bf16_f32 v117, v74, v75
    v_cvt_pk_bf16_f32 v118, v76, v77
    v_cvt_pk_bf16_f32 v119, v78, v79
    s_nop 0
    v_permlane16_swap_b32 v116, v118
    v_permlane16_swap_b32 v117, v119
    v_lshlrev_b32 v32, 16, v116
    v_and_b32 v33, s39, v116
    v_lshlrev_b32 v34, 16, v117
    v_and_b32 v35, s39, v117
    v_lshlrev_b32 v36, 16, v118
    v_and_b32 v37, s39, v118
    v_lshlrev_b32 v38, 16, v119
    v_and_b32 v39, s39, v119
    v_add_f32 v32, v32, v40
    v_add_f32 v33, v33, v41
    v_add_f32 v34, v34, v42
    v_add_f32 v35, v35, v43
    v_add_f32 v36, v36, v44
    v_add_f32 v37, v37, v45
    v_add_f32 v38, v38, v46
    v_add_f32 v39, v39, v47
    v_cvt_pk_bf16_f32 v188, v32, v33
    v_cvt_pk_bf16_f32 v189, v34, v35
    v_cvt_pk_bf16_f32 v190, v36, v37
    v_cvt_pk_bf16_f32 v191, v38, v39
    ds_write_b128 v177, v[188:191]
    s_mov_b64 exec, 1
    ds_add_u32 v6, v5 offset:28
    s_mov_b64 exec, -1
    s_mov_b32 s63, 32768
BW_21:
    ds_read_b32 v157, v6 offset:28
    s_waitcnt lgkmcnt(0)
    v_readfirstlane_b32 s62, v157
    s_nop 0
    s_cmp_ge_u32 s62, 4
    s_cbranch_scc1 BD_22
    s_sub_u32 s63, s63, 1
    s_cmp_lg_u32 s63, 0
    s_cbranch_scc1 BW_21
BD_22:
    ds_read2_b32 v[196:197], v192 offset0:0 offset1:1
    ds_read_b32 v198, v192 offset:8
    ds_read2_b32 v[200:201], v193 offset0:0 offset1:1
    ds_read_b32 v202, v193 offset:8
    ds_read2_b32 v[204:205], v194 offset0:0 offset1:1
    ds_read_b32 v206, v194 offset:8
    s_waitcnt lgkmcnt(4)
    buffer_store_dwordx4 v[196:199], v156, s[24:27], s46 offen offset:0 sc1
    s_waitcnt lgkmcnt(2)
    buffer_store_dwordx4 v[200:203], v156, s[24:27], s46 offen offset:2048 sc1
    s_waitcnt lgkmcnt(0)
    buffer_store_dwordx4 v[204:207], v156, s[24:27], s47 offen offset:0 sc1
    s_or_b32 s48, s2, s3
    s_cmp_lg_u32 s48, 0
    s_cbranch_scc1 F_NOPUB
    s_mov_b32 s48, 22740992
    v_mov_b32 v7, s38
    s_mov_b64 exec, 1
    buffer_store_dword v7, v4, s[24:27], s48 offen sc1
    s_mov_b64 exec, -1
F_NOPUB:
F_EXIT:
    s_endpgm
G_START:
    s_and_b32 s48, s37, 3
    s_mul_i32 s41, s45, 43
    s_lshr_b32 s41, s41, 3
    s_mul_i32 s48, s48, 11
    s_xor_b32 s92, s53, 1
    s_lshl_b32 s92, s92, 7
    s_add_u32 s92, s92, s50
    s_add_u32 s41, s41, s48
    s_cmp_ge_u32 s41, 43
    s_cselect_b32 s48, 43, 0
    s_sub_u32 s41, s41, s48
    s_add_u32 m0, s51, 16384
    s_mul_i32 s48, s36, 5
    s_add_u32 s41, s41, s48
    s_cmp_ge_u32 s41, 43
    s_cselect_b32 s48, 43, 0
    buffer_load_dwordx4 v48, s[4:7], s92 offen offset:0 lds
    s_sub_u32 s41, s41, s48
    s_mul_i32 s41, s41, 1024
    s_lshl_b32 s48, s3, 2
    s_add_u32 s48, s48, 162048
    buffer_load_dwordx4 v49, s[4:7], s92 offen offset:1024 lds
    v_mov_b32 v17, s48
    v_lshrrev_b32 v18, 1, v2
    v_lshrrev_b32 v19, 1, v3
    v_xor_b32 v18, v18, v19
    buffer_load_dwordx4 v48, s[4:7], s92 offen offset:2048 lds
    v_lshl_add_u32 v19, v2, 7, s51
    v_lshl_add_u32 v18, v18, 4, v19
    v_and_b32 v19, 1, v3
    v_lshl_add_u32 v50, v19, 11, v18
    buffer_load_dwordx4 v49, s[4:7], s92 offen offset:3072 lds
    v_xor_b32 v51, 32, v50
    v_xor_b32 v52, 64, v50
    v_xor_b32 v53, 96, v50
    v_lshrrev_b32 v18, 2, v2
    s_xor_b32 s93, s53, 1
    s_mul_i32 s93, s93, 176128
    v_lshrrev_b32 v19, 1, v3
    v_lshl_add_u32 v18, v19, 3, v18
    v_mul_u32_u24 v18, 192, v18
    v_xor_b32 v19, v19, v3
    s_add_u32 m0, s52, 12288
    v_and_b32 v19, 1, v19
    v_lshl_add_u32 v18, v19, 5, v18
    v_and_b32 v19, 3, v2
    v_lshl_add_u32 v20, v19, 3, v18
    buffer_load_dwordx4 v216, s[16:19], s93 offen offset:0 lds
    v_lshrrev_b32 v18, 5, v1
    v_lshlrev_b32 v18, 4, v18
    s_add_u32 s48, s3, 0
    s_cmp_ge_u32 s48, 3
    s_cselect_b32 s49, 3, 0
    buffer_load_dwordx4 v217, s[16:19], s93 offen offset:1024 lds
    s_sub_u32 s48, s48, s49
    s_lshl_b32 s49, s48, 6
    v_add_u32 v219, s49, v20
    s_lshl_b32 s49, s48, 11
    buffer_load_dwordx4 v218, s[16:19], s93 offen offset:2048 lds
    v_add_u32 v222, s49, v15
    s_lshl_b32 s49, s48, 7
    s_add_u32 s49, s49, 163328
    v_add_u32 v225, s49, v18
    s_xor_b32 s92, s53, 2
    s_lshl_b32 s92, s92, 7
    s_add_u32 s92, s92, s50
    v_lshlrev_b32 v19, 4, v3
    v_lshl_add_u32 v19, v2, 6, v19
    v_add_u32 v55, s49, v19
    s_xor_b32 s49, s43, 14
    s_add_u32 m0, s51, 32768
    s_cmp_eq_u32 s48, 0
    s_cselect_b32 s49, 1, s49
    s_cmp_lg_u32 s49, 0
    s_cselect_b32 s86, -1, 0
    buffer_load_dwordx4 v48, s[4:7], s92 offen offset:0 lds
    s_mov_b32 s87, s86
    s_add_u32 s48, s3, 1
    s_cmp_ge_u32 s48, 3
    s_cselect_b32 s49, 3, 0
    buffer_load_dwordx4 v49, s[4:7], s92 offen offset:1024 lds
    s_sub_u32 s48, s48, s49
    s_lshl_b32 s49, s48, 6
    v_add_u32 v220, s49, v20
    s_lshl_b32 s49, s48, 11
    buffer_load_dwordx4 v48, s[4:7], s92 offen offset:2048 lds
    v_add_u32 v223, s49, v15
    s_lshl_b32 s49, s48, 7
    s_add_u32 s49, s49, 163328
    v_add_u32 v226, s49, v18
    buffer_load_dwordx4 v49, s[4:7], s92 offen offset:3072 lds
    s_xor_b32 s49, s43, 14
    s_cmp_eq_u32 s48, 0
    s_cselect_b32 s49, 1, s49
    s_cmp_lg_u32 s49, 0
    s_cselect_b32 s88, -1, 0
    s_xor_b32 s93, s53, 2
    s_mul_i32 s93, s93, 176128
    s_mov_b32 s89, s88
    s_add_u32 s48, s3, 2
    s_cmp_ge_u32 s48, 3
    s_cselect_b32 s49, 3, 0
    s_add_u32 m0, s52, 24576
    s_sub_u32 s48, s48, s49
    s_lshl_b32 s49, s48, 6
    v_add_u32 v221, s49, v20
    s_lshl_b32 s49, s48, 11
    buffer_load_dwordx4 v216, s[16:19], s93 offen offset:0 lds
    v_add_u32 v224, s49, v15
    s_lshl_b32 s49, s48, 7
    s_add_u32 s49, s49, 163328
    v_add_u32 v227, s49, v18
    buffer_load_dwordx4 v217, s[16:19], s93 offen offset:1024 lds
    s_xor_b32 s49, s43, 14
    s_cmp_eq_u32 s48, 0
    s_cselect_b32 s49, 1, s49
    s_cmp_lg_u32 s49, 0
    s_cselect_b32 s90, -1, 0
    buffer_load_dwordx4 v218, s[16:19], s93 offen offset:2048 lds
    s_mov_b32 s91, s90
    v_xor_b32 v18, v2, v3
    v_and_b32 v18, 1, v18
    v_subrev_u32 v18, 1, v18
    v_and_b32 v212, 0x3f803f80, v18
    v_mov_b32 v213, v212
    v_mov_b32 v214, v212
    v_mov_b32 v215, v212
    s_mov_b32 s94, 0x30003
    s_mov_b32 s95, 0x30003
    v_lshrrev_b32 v18, 3, v1
    v_bfe_u32 v19, v1, 4, 1
    v_lshlrev_b32 v19, 2, v19
    v_and_b32 v20, 7, v1
    v_xor_b32 v20, v20, v19
    v_lshlrev_b32 v18, 10, v18
    v_lshl_add_u32 v8, v20, 4, v18
    s_lshl_b32 s48, s3, 13
    s_lshl_b32 s49, s45, 7
    s_add_u32 s48, s48, s49
    v_add_u32 v8, s48, v8
    v_lshrrev_b32 v18, 2, v2
    v_lshrrev_b32 v19, 1, v3
    v_lshl_add_u32 v18, v19, 2, v18
    v_lshlrev_b32 v18, 7, v18
    v_and_b32 v19, 3, v2
    v_lshl_add_u32 v18, v19, 3, v18
    v_and_b32 v19, 1, v3
    v_lshl_add_u32 v18, v19, 5, v18
    v_lshrrev_b32 v19, 3, v2
    v_lshl_add_u32 v18, v19, 6, v18
    s_and_b32 s62, s3, 1
    s_lshl_b32 s62, s62, 11
    v_add_u32 v232, s62, v18
    v_xor_b32 v233, 64, v232
    v_add_u32 v234, 0x10000, v232
    v_add_u32 v236, 0x20000, v232
    v_add_u32 v235, 0x10000, v233
    v_add_u32 v237, 0x20000, v233
    s_lshl_b32 s48, s42, 2
    s_add_u32 s48, s48, s3
    s_mul_i32 s57, s48, 88064
    s_mul_i32 s49, s43, 6144
    s_add_u32 s57, s57, s49
    s_add_u32 s57, s57, 13631488
    s_lshl_b32 s48, s48, 11
    s_add_u32 s56, s48, 22151168
    s_lshl_b32 s49, s43, 7
    s_add_u32 s56, s56, s49
    v_and_b32 v23, 31, v1
    v_lshlrev_b32 v23, 4, v23
    s_waitcnt vmcnt(14)
    ds_add_u32 v9, v5
    ds_read_b128 v[104:107], v50 offset:0
    ds_read_b128 v[108:111], v51 offset:0
    ds_read_b128 v[112:115], v52 offset:0
    ds_read_b128 v[116:119], v53 offset:0
    s_mov_b32 s63, 32768
PW_23:
    ds_read_b32 v12, v11
    s_waitcnt lgkmcnt(0)
    v_cmp_gt_u32 vcc, 1, v12
    s_nop 1
    s_cbranch_vccz PD_24
    s_sub_u32 s63, s63, 1
    s_cmp_lg_u32 s63, 0
    s_cbranch_scc1 PW_23
PD_24:
    ds_read_b64_tr_b16 v[24:25], v219 offset:0
    ds_read_b64_tr_b16 v[26:27], v219 offset:768
    ds_read_b64_tr_b16 v[28:29], v220 offset:0
    ds_read_b64_tr_b16 v[30:31], v220 offset:768
    ds_read_b64_tr_b16 v[32:33], v221 offset:0
    ds_read_b64_tr_b16 v[34:35], v221 offset:768
    ds_read_b64_tr_b16 v[36:37], v219 offset:3072
    ds_read_b64_tr_b16 v[38:39], v219 offset:3840
    ds_read_b64_tr_b16 v[40:41], v220 offset:3072
    ds_read_b64_tr_b16 v[42:43], v220 offset:3840
    s_waitcnt lgkmcnt(8)
    v_mfma_f32_32x32x16_bf16 v[56:71], v[24:27], v[104:107], 0
    ds_read_b64_tr_b16 v[44:45], v221 offset:3072
    ds_read_b64_tr_b16 v[46:47], v221 offset:3840
    s_xor_b32 s92, s53, 3
    s_lshl_b32 s92, s92, 7
    s_add_u32 s92, s92, s50
    s_add_u32 m0, s51, 49152
    v_mfma_f32_16x16x32_bf16 v[208:211], v[24:27], v[212:215], 0
    buffer_load_dwordx4 v48, s[4:7], s92 offen offset:0 lds
    s_waitcnt lgkmcnt(8)
    v_mfma_f32_32x32x16_bf16 v[72:87], v[28:31], v[104:107], 0
    ds_read_b64_tr_b16 v[24:25], v219 offset:6144
    ds_read_b64_tr_b16 v[26:27], v219 offset:6912
    s_waitcnt vmcnt(8)
    ds_add_u32 v9, v5
    ds_read_b128 v[120:123], v50 offset:16384
    s_waitcnt lgkmcnt(10)
    v_mfma_f32_32x32x16_bf16 v[88:103], v[32:35], v[104:107], 0
    ds_read_b64_tr_b16 v[28:29], v220 offset:6144
    ds_read_b64_tr_b16 v[30:31], v220 offset:6912
    buffer_load_dwordx4 v49, s[4:7], s92 offen offset:1024 lds
    ds_read_b128 v[124:127], v51 offset:16384
    s_waitcnt lgkmcnt(11)
    v_mfma_f32_32x32x16_bf16 v[56:71], v[36:39], v[108:111], v[56:71]
    ds_read_b64_tr_b16 v[32:33], v221 offset:6144
    ds_read_b64_tr_b16 v[34:35], v221 offset:6912
    ds_read_b128 v[128:131], v52 offset:16384
    ds_read_b128 v[132:135], v53 offset:16384
    v_mfma_f32_16x16x32_bf16 v[208:211], v[36:39], v[212:215], v[208:211]
    buffer_load_dwordx4 v48, s[4:7], s92 offen offset:2048 lds
    ds_read_b32 v12, v11
    s_waitcnt lgkmcnt(14)
    v_mfma_f32_32x32x16_bf16 v[72:87], v[40:43], v[108:111], v[72:87]
    ds_read_b64_tr_b16 v[36:37], v219 offset:9216
    ds_read_b64_tr_b16 v[38:39], v219 offset:9984
    s_waitcnt lgkmcnt(14)
    v_mfma_f32_32x32x16_bf16 v[88:103], v[44:47], v[108:111], v[88:103]
    ds_read_b64_tr_b16 v[40:41], v220 offset:9216
    ds_read_b64_tr_b16 v[42:43], v220 offset:9984
    buffer_load_dwordx4 v49, s[4:7], s92 offen offset:3072 lds
    s_xor_b32 s93, s53, 3
    s_mul_i32 s93, s93, 176128
    s_waitcnt lgkmcnt(14)
    v_mfma_f32_32x32x16_bf16 v[56:71], v[24:27], v[112:115], v[56:71]
    ds_read_b64_tr_b16 v[44:45], v221 offset:9216
    ds_read_b64_tr_b16 v[46:47], v221 offset:9984
    s_waitcnt lgkmcnt(6)
    v_cmp_gt_u32 vcc, 2, v12
    s_cbranch_vccnz PS_25
PB_26:
    v_mfma_f32_16x16x32_bf16 v[208:211], v[24:27], v[212:215], v[208:211]
    s_add_u32 m0, s52, 36864
    s_nop 0
    buffer_load_dwordx4 v216, s[16:19], s93 offen offset:0 lds
    v_mfma_f32_32x32x16_bf16 v[72:87], v[28:31], v[112:115], v[72:87]
    ds_read_b64_tr_b16 v[24:25], v219 offset:12288
    ds_read_b64_tr_b16 v[26:27], v219 offset:13056
    v_mfma_f32_32x32x16_bf16 v[88:103], v[32:35], v[112:115], v[88:103]
    ds_read_b64_tr_b16 v[28:29], v220 offset:12288
    ds_read_b64_tr_b16 v[30:31], v220 offset:13056
    buffer_load_dwordx4 v217, s[16:19], s93 offen offset:1024 lds
    s_waitcnt lgkmcnt(8)
    v_mfma_f32_32x32x16_bf16 v[56:71], v[36:39], v[116:119], v[56:71]
    ds_read_b64_tr_b16 v[32:33], v221 offset:12288
    ds_read_b64_tr_b16 v[34:35], v221 offset:13056
    v_mfma_f32_16x16x32_bf16 v[208:211], v[36:39], v[212:215], v[208:211]
    buffer_load_dwordx4 v218, s[16:19], s93 offen offset:2048 lds
    s_waitcnt lgkmcnt(8)
    v_mfma_f32_32x32x16_bf16 v[72:87], v[40:43], v[116:119], v[72:87]
    ds_read_b64_tr_b16 v[36:37], v219 offset:15360
    ds_read_b64_tr_b16 v[38:39], v219 offset:16128
    s_waitcnt lgkmcnt(8)
    v_mfma_f32_32x32x16_bf16 v[88:103], v[44:47], v[116:119], v[88:103]
    ds_read_b64_tr_b16 v[40:41], v220 offset:15360
    ds_read_b64_tr_b16 v[42:43], v220 offset:16128
    s_waitcnt lgkmcnt(8)
    v_mfma_f32_32x32x16_bf16 v[56:71], v[24:27], v[120:123], v[56:71]
    ds_read_b64_tr_b16 v[44:45], v221 offset:15360
    ds_read_b64_tr_b16 v[46:47], v221 offset:16128
    s_xor_b32 s92, s53, 4
    s_lshl_b32 s92, s92, 7
    s_add_u32 s92, s92, s50
    s_add_u32 m0, s51, 0
    v_mfma_f32_16x16x32_bf16 v[208:211], v[24:27], v[212:215], v[208:211]
    buffer_load_dwordx4 v48, s[4:7], s92 offen offset:0 lds
    s_waitcnt lgkmcnt(8)
    v_mfma_f32_32x32x16_bf16 v[72:87], v[28:31], v[120:123], v[72:87]
    ds_read_b64_tr_b16 v[24:25], v219 offset:18432
    ds_read_b64_tr_b16 v[26:27], v219 offset:19200
    s_waitcnt vmcnt(8)
    ds_add_u32 v9, v5
    ds_read_b128 v[104:107], v50 offset:32768
    s_waitcnt lgkmcnt(10)
    v_mfma_f32_32x32x16_bf16 v[88:103], v[32:35], v[120:123], v[88:103]
    ds_read_b64_tr_b16 v[28:29], v220 offset:18432
    ds_read_b64_tr_b16 v[30:31], v220 offset:19200
    buffer_load_dwordx4 v49, s[4:7], s92 offen offset:1024 lds
    ds_read_b128 v[108:111], v51 offset:32768
    s_waitcnt lgkmcnt(11)
    v_mfma_f32_32x32x16_bf16 v[56:71], v[36:39], v[124:127], v[56:71]
    ds_read_b64_tr_b16 v[32:33], v221 offset:18432
    ds_read_b64_tr_b16 v[34:35], v221 offset:19200
    ds_read_b128 v[112:115], v52 offset:32768
    ds_read_b128 v[116:119], v53 offset:32768
    v_mfma_f32_16x16x32_bf16 v[208:211], v[36:39], v[212:215], v[208:211]
    buffer_load_dwordx4 v48, s[4:7], s92 offen offset:2048 lds
    ds_read_b32 v12, v11
    s_waitcnt lgkmcnt(14)
    v_mfma_f32_32x32x16_bf16 v[72:87], v[40:43], v[124:127], v[72:87]
    ds_read_b64_tr_b16 v[36:37], v219 offset:21504
    ds_read_b64_tr_b16 v[38:39], v219 offset:22272
    s_waitcnt lgkmcnt(14)
    v_mfma_f32_32x32x16_bf16 v[88:103], v[44:47], v[124:127], v[88:103]
    ds_read_b64_tr_b16 v[40:41], v220 offset:21504
    ds_read_b64_tr_b16 v[42:43], v220 offset:22272
    buffer_load_dwordx4 v49, s[4:7], s92 offen offset:3072 lds
    s_xor_b32 s93, s53, 4
    s_mul_i32 s93, s93, 176128
    s_waitcnt lgkmcnt(14)
    v_mfma_f32_32x32x16_bf16 v[56:71], v[24:27], v[128:131], v[56:71]
    ds_read_b64_tr_b16 v[44:45], v221 offset:21504
    ds_read_b64_tr_b16 v[46:47], v221 offset:22272
    s_waitcnt lgkmcnt(6)
    v_cmp_gt_u32 vcc, 3, v12
    s_cbranch_vccnz PS_27
PB_28:
    v_mfma_f32_16x16x32_bf16 v[208:211], v[24:27], v[212:215], v[208:211]
    s_add_u32 m0, s52, 49152
    s_nop 0
    buffer_load_dwordx4 v216, s[16:19], s93 offen offset:0 lds
    v_mfma_f32_32x32x16_bf16 v[72:87], v[28:31], v[128:131], v[72:87]
    ds_read_b64_tr_b16 v[24:25], v219 offset:24576
    ds_read_b64_tr_b16 v[26:27], v219 offset:25344
    v_mfma_f32_32x32x16_bf16 v[88:103], v[32:35], v[128:131], v[88:103]
    ds_read_b64_tr_b16 v[28:29], v220 offset:24576
    ds_read_b64_tr_b16 v[30:31], v220 offset:25344
    buffer_load_dwordx4 v217, s[16:19], s93 offen offset:1024 lds
    s_waitcnt lgkmcnt(8)
    v_mfma_f32_32x32x16_bf16 v[56:71], v[36:39], v[132:135], v[56:71]
    ds_read_b64_tr_b16 v[32:33], v221 offset:24576
    ds_read_b64_tr_b16 v[34:35], v221 offset:25344
    v_mfma_f32_16x16x32_bf16 v[208:211], v[36:39], v[212:215], v[208:211]
    buffer_load_dwordx4 v218, s[16:19], s93 offen offset:2048 lds
    s_waitcnt lgkmcnt(8)
    v_mfma_f32_32x32x16_bf16 v[72:87], v[40:43], v[132:135], v[72:87]
    ds_read_b64_tr_b16 v[36:37], v219 offset:27648
    ds_read_b64_tr_b16 v[38:39], v219 offset:28416
    s_waitcnt lgkmcnt(8)
    v_mfma_f32_32x32x16_bf16 v[88:103], v[44:47], v[132:135], v[88:103]
    ds_read_b64_tr_b16 v[40:41], v220 offset:27648
    ds_read_b64_tr_b16 v[42:43], v220 offset:28416
    s_waitcnt lgkmcnt(8)
    v_mfma_f32_32x32x16_bf16 v[56:71], v[24:27], v[104:107], v[56:71]
    ds_read_b64_tr_b16 v[44:45], v221 offset:27648
    ds_read_b64_tr_b16 v[46:47], v221 offset:28416
    s_xor_b32 s92, s53, 5
    s_lshl_b32 s92, s92, 7
    s_add_u32 s92, s92, s50
    s_add_u32 m0, s51, 16384
    v_mfma_f32_16x16x32_bf16 v[208:211], v[24:27], v[212:215], v[208:211]
    buffer_load_dwordx4 v48, s[4:7], s92 offen offset:0 lds
    s_waitcnt lgkmcnt(8)
    v_mfma_f32_32x32x16_bf16 v[72:87], v[28:31], v[104:107], v[72:87]
    ds_read_b64_tr_b16 v[24:25], v219 offset:30720
    ds_read_b64_tr_b16 v[26:27], v219 offset:31488
    s_waitcnt vmcnt(8)
    ds_add_u32 v9, v5
    ds_read_b128 v[120:123], v50 offset:49152
    s_waitcnt lgkmcnt(10)
    v_mfma_f32_32x32x16_bf16 v[88:103], v[32:35], v[104:107], v[88:103]
    ds_read_b64_tr_b16 v[28:29], v220 offset:30720
    ds_read_b64_tr_b16 v[30:31], v220 offset:31488
    buffer_load_dwordx4 v49, s[4:7], s92 offen offset:1024 lds
    ds_read_b128 v[124:127], v51 offset:49152
    s_waitcnt lgkmcnt(11)
    v_mfma_f32_32x32x16_bf16 v[56:71], v[36:39], v[108:111], v[56:71]
    ds_read_b64_tr_b16 v[32:33], v221 offset:30720
    ds_read_b64_tr_b16 v[34:35], v221 offset:31488
    ds_read_b128 v[128:131], v52 offset:49152
    ds_read_b128 v[132:135], v53 offset:49152
    v_mfma_f32_16x16x32_bf16 v[208:211], v[36:39], v[212:215], v[208:211]
    buffer_load_dwordx4 v48, s[4:7], s92 offen offset:2048 lds
    ds_read_b32 v12, v11
    s_waitcnt lgkmcnt(14)
    v_mfma_f32_32x32x16_bf16 v[72:87], v[40:43], v[108:111], v[72:87]
    ds_read_b64_tr_b16 v[36:37], v219 offset:33792
    ds_read_b64_tr_b16 v[38:39], v219 offset:34560
    s_waitcnt lgkmcnt(14)
    v_mfma_f32_32x32x16_bf16 v[88:103], v[44:47], v[108:111], v[88:103]
    ds_read_b64_tr_b16 v[40:41], v220 offset:33792
    ds_read_b64_tr_b16 v[42:43], v220 offset:34560
    buffer_load_dwordx4 v49, s[4:7], s92 offen offset:3072 lds
    s_xor_b32 s93, s53, 5
    s_mul_i32 s93, s93, 176128
    s_waitcnt lgkmcnt(14)
    v_mfma_f32_32x32x16_bf16 v[56:71], v[24:27], v[112:115], v[56:71]
    ds_read_b64_tr_b16 v[44:45], v221 offset:33792
    ds_read_b64_tr_b16 v[46:47], v221 offset:34560
    s_waitcnt lgkmcnt(6)
    v_cmp_gt_u32 vcc, 4, v12
    s_cbranch_vccnz PS_29
PB_30:
    v_mfma_f32_16x16x32_bf16 v[208:211], v[24:27], v[212:215], v[208:211]
    s_add_u32 m0, s52, 0
    s_nop 0
    buffer_load_dwordx4 v216, s[16:19], s93 offen offset:0 lds
    v_mfma_f32_32x32x16_bf16 v[72:87], v[28:31], v[112:115], v[72:87]
    ds_read_b64_tr_b16 v[24:25], v219 offset:36864
    ds_read_b64_tr_b16 v[26:27], v219 offset:37632
    v_mfma_f32_32x32x16_bf16 v[88:103], v[32:35], v[112:115], v[88:103]
    ds_read_b64_tr_b16 v[28:29], v220 offset:36864
    ds_read_b64_tr_b16 v[30:31], v220 offset:37632
    buffer_load_dwordx4 v217, s[16:19], s93 offen offset:1024 lds
    s_waitcnt lgkmcnt(8)
    v_mfma_f32_32x32x16_bf16 v[56:71], v[36:39], v[116:119], v[56:71]
    ds_read_b64_tr_b16 v[32:33], v221 offset:36864
    ds_read_b64_tr_b16 v[34:35], v221 offset:37632
    v_mfma_f32_16x16x32_bf16 v[208:211], v[36:39], v[212:215], v[208:211]
    buffer_load_dwordx4 v218, s[16:19], s93 offen offset:2048 lds
    s_waitcnt lgkmcnt(8)
    v_mfma_f32_32x32x16_bf16 v[72:87], v[40:43], v[116:119], v[72:87]
    ds_read_b64_tr_b16 v[36:37], v219 offset:39936
    ds_read_b64_tr_b16 v[38:39], v219 offset:40704
    s_waitcnt lgkmcnt(8)
    v_mfma_f32_32x32x16_bf16 v[88:103], v[44:47], v[116:119], v[88:103]
    ds_read_b64_tr_b16 v[40:41], v220 offset:39936
    ds_read_b64_tr_b16 v[42:43], v220 offset:40704
    s_waitcnt lgkmcnt(8)
    v_mfma_f32_32x32x16_bf16 v[56:71], v[24:27], v[120:123], v[56:71]
    ds_read_b64_tr_b16 v[44:45], v221 offset:39936
    ds_read_b64_tr_b16 v[46:47], v221 offset:40704
    s_xor_b32 s92, s53, 6
    s_lshl_b32 s92, s92, 7
    s_add_u32 s92, s92, s50
    s_add_u32 m0, s51, 32768
    v_mfma_f32_16x16x32_bf16 v[208:211], v[24:27], v[212:215], v[208:211]
    buffer_load_dwordx4 v48, s[4:7], s92 offen offset:0 lds
    s_waitcnt lgkmcnt(8)
    v_mfma_f32_32x32x16_bf16 v[72:87], v[28:31], v[120:123], v[72:87]
    ds_read_b64_tr_b16 v[24:25], v219 offset:43008
    ds_read_b64_tr_b16 v[26:27], v219 offset:43776
    s_waitcnt vmcnt(8)
    ds_add_u32 v9, v5
    ds_read_b128 v[104:107], v50 offset:0
    s_waitcnt lgkmcnt(10)
    v_mfma_f32_32x32x16_bf16 v[88:103], v[32:35], v[120:123], v[88:103]
    ds_read_b64_tr_b16 v[28:29], v220 offset:43008
    ds_read_b64_tr_b16 v[30:31], v220 offset:43776
    buffer_load_dwordx4 v49, s[4:7], s92 offen offset:1024 lds
    ds_read_b128 v[108:111], v51 offset:0
    s_waitcnt lgkmcnt(11)
    v_mfma_f32_32x32x16_bf16 v[56:71], v[36:39], v[124:127], v[56:71]
    ds_read_b64_tr_b16 v[32:33], v221 offset:43008
    ds_read_b64_tr_b16 v[34:35], v221 offset:43776
    ds_read_b128 v[112:115], v52 offset:0
    ds_read_b128 v[116:119], v53 offset:0
    v_mfma_f32_16x16x32_bf16 v[208:211], v[36:39], v[212:215], v[208:211]
    buffer_load_dwordx4 v48, s[4:7], s92 offen offset:2048 lds
    ds_read_b32 v12, v11
    s_waitcnt lgkmcnt(14)
    v_mfma_f32_32x32x16_bf16 v[72:87], v[40:43], v[124:127], v[72:87]
    ds_read_b64_tr_b16 v[36:37], v219 offset:46080
    ds_read_b64_tr_b16 v[38:39], v219 offset:46848
    s_waitcnt lgkmcnt(14)
    v_mfma_f32_32x32x16_bf16 v[88:103], v[44:47], v[124:127], v[88:103]
    ds_read_b64_tr_b16 v[40:41], v220 offset:46080
    ds_read_b64_tr_b16 v[42:43], v220 offset:46848
    buffer_load_dwordx4 v49, s[4:7], s92 offen offset:3072 lds
    s_xor_b32 s93, s53, 6
    s_mul_i32 s93, s93, 176128
    s_waitcnt lgkmcnt(14)
    v_mfma_f32_32x32x16_bf16 v[56:71], v[24:27], v[128:131], v[56:71]
    ds_read_b64_tr_b16 v[44:45], v221 offset:46080
    ds_read_b64_tr_b16 v[46:47], v221 offset:46848
    s_waitcnt lgkmcnt(6)
    v_cmp_gt_u32 vcc, 5, v12
    s_cbranch_vccnz PS_31
PB_32:
    v_mfma_f32_16x16x32_bf16 v[208:211], v[24:27], v[212:215], v[208:211]
    s_add_u32 m0, s52, 12288
    s_nop 0
    buffer_load_dwordx4 v216, s[16:19], s93 offen offset:0 lds
    v_mfma_f32_32x32x16_bf16 v[72:87], v[28:31], v[128:131], v[72:87]
    ds_read_b64_tr_b16 v[24:25], v219 offset:49152
    ds_read_b64_tr_b16 v[26:27], v219 offset:49920
    v_mfma_f32_32x32x16_bf16 v[88:103], v[32:35], v[128:131], v[88:103]
    ds_read_b64_tr_b16 v[28:29], v220 offset:49152
    ds_read_b64_tr_b16 v[30:31], v220 offset:49920
    buffer_load_dwordx4 v217, s[16:19], s93 offen offset:1024 lds
    s_waitcnt lgkmcnt(8)
    v_mfma_f32_32x32x16_bf16 v[56:71], v[36:39], v[132:135], v[56:71]
    ds_read_b64_tr_b16 v[32:33], v221 offset:49152
    ds_read_b64_tr_b16 v[34:35], v221 offset:49920
    v_mfma_f32_16x16x32_bf16 v[208:211], v[36:39], v[212:215], v[208:211]
    buffer_load_dwordx4 v218, s[16:19], s93 offen offset:2048 lds
    s_waitcnt lgkmcnt(8)
    v_mfma_f32_32x32x16_bf16 v[72:87], v[40:43], v[132:135], v[72:87]
    ds_read_b64_tr_b16 v[36:37], v219 offset:52224
    ds_read_b64_tr_b16 v[38:39], v219 offset:52992
    s_waitcnt lgkmcnt(8)
    v_mfma_f32_32x32x16_bf16 v[88:103], v[44:47], v[132:135], v[88:103]
    ds_read_b64_tr_b16 v[40:41], v220 offset:52224
    ds_read_b64_tr_b16 v[42:43], v220 offset:52992
    s_waitcnt lgkmcnt(8)
    v_mfma_f32_32x32x16_bf16 v[56:71], v[24:27], v[104:107], v[56:71]
    ds_read_b64_tr_b16 v[44:45], v221 offset:52224
    ds_read_b64_tr_b16 v[46:47], v221 offset:52992
    s_xor_b32 s92, s53, 7
    s_lshl_b32 s92, s92, 7
    s_add_u32 s92, s92, s50
    s_add_u32 m0, s51, 49152
    v_mfma_f32_16x16x32_bf16 v[208:211], v[24:27], v[212:215], v[208:211]
    buffer_load_dwordx4 v48, s[4:7], s92 offen offset:0 lds
    s_waitcnt lgkmcnt(8)
    v_mfma_f32_32x32x16_bf16 v[72:87], v[28:31], v[104:107], v[72:87]
    ds_read_b64_tr_b16 v[24:25], v219 offset:55296
    ds_read_b64_tr_b16 v[26:27], v219 offset:56064
    s_waitcnt vmcnt(8)
    ds_add_u32 v9, v5
    ds_read_b128 v[120:123], v50 offset:16384
    s_waitcnt lgkmcnt(10)
    v_mfma_f32_32x32x16_bf16 v[88:103], v[32:35], v[104:107], v[88:103]
    ds_read_b64_tr_b16 v[28:29], v220 offset:55296
    ds_read_b64_tr_b16 v[30:31], v220 offset:56064
    buffer_load_dwordx4 v49, s[4:7], s92 offen offset:1024 lds
    ds_read_b128 v[124:127], v51 offset:16384
    s_waitcnt lgkmcnt(11)
    v_mfma_f32_32x32x16_bf16 v[56:71], v[36:39], v[108:111], v[56:71]
    ds_read_b64_tr_b16 v[32:33], v221 offset:55296
    ds_read_b64_tr_b16 v[34:35], v221 offset:56064
    ds_read_b128 v[128:131], v52 offset:16384
    ds_read_b128 v[132:135], v53 offset:16384
    v_mfma_f32_16x16x32_bf16 v[208:211], v[36:39], v[212:215], v[208:211]
    buffer_load_dwordx4 v48, s[4:7], s92 offen offset:2048 lds
    ds_read_b32 v12, v11
    s_waitcnt lgkmcnt(14)
    v_mfma_f32_32x32x16_bf16 v[72:87], v[40:43], v[108:111], v[72:87]
    ds_read_b64_tr_b16 v[36:37], v219 offset:58368
    ds_read_b64_tr_b16 v[38:39], v219 offset:59136
    s_waitcnt lgkmcnt(14)
    v_mfma_f32_32x32x16_bf16 v[88:103], v[44:47], v[108:111], v[88:103]
    ds_read_b64_tr_b16 v[40:41], v220 offset:58368
    ds_read_b64_tr_b16 v[42:43], v220 offset:59136
    buffer_load_dwordx4 v49, s[4:7], s92 offen offset:3072 lds
    s_xor_b32 s93, s53, 7
    s_mul_i32 s93, s93, 176128
    s_waitcnt lgkmcnt(14)
    v_mfma_f32_32x32x16_bf16 v[56:71], v[24:27], v[112:115], v[56:71]
    ds_read_b64_tr_b16 v[44:45], v221 offset:58368
    ds_read_b64_tr_b16 v[46:47], v221 offset:59136
    s_waitcnt lgkmcnt(6)
    v_cmp_gt_u32 vcc, 6, v12
    s_cbranch_vccnz PS_33
PB_34:
    v_mfma_f32_16x16x32_bf16 v[208:211], v[24:27], v[212:215], v[208:211]
    s_add_u32 m0, s52, 24576
    s_nop 0
    buffer_load_dwordx4 v216, s[16:19], s93 offen offset:0 lds
    v_mfma_f32_32x32x16_bf16 v[72:87], v[28:31], v[112:115], v[72:87]
    ds_read_b64_tr_b16 v[24:25], v219 offset:0
    ds_read_b64_tr_b16 v[26:27], v219 offset:768
    v_mfma_f32_32x32x16_bf16 v[88:103], v[32:35], v[112:115], v[88:103]
    ds_read_b64_tr_b16 v[28:29], v220 offset:0
    ds_read_b64_tr_b16 v[30:31], v220 offset:768
    buffer_load_dwordx4 v217, s[16:19], s93 offen offset:1024 lds
    s_waitcnt lgkmcnt(8)
    v_mfma_f32_32x32x16_bf16 v[56:71], v[36:39], v[116:119], v[56:71]
    ds_read_b64_tr_b16 v[32:33], v221 offset:0
    ds_read_b64_tr_b16 v[34:35], v221 offset:768
    v_mfma_f32_16x16x32_bf16 v[208:211], v[36:39], v[212:215], v[208:211]
    buffer_load_dwordx4 v218, s[16:19], s93 offen offset:2048 lds
    s_add_u32 m0, s46, 73728
    s_lshl_b32 s60, s41, 5
    s_waitcnt lgkmcnt(8)
    v_mfma_f32_32x32x16_bf16 v[72:87], v[40:43], v[116:119], v[72:87]
    ds_read_b64_tr_b16 v[36:37], v219 offset:3072
    ds_read_b64_tr_b16 v[38:39], v219 offset:3840
    s_waitcnt lgkmcnt(8)
    v_mfma_f32_32x32x16_bf16 v[88:103], v[44:47], v[116:119], v[88:103]
    ds_read_b64_tr_b16 v[40:41], v220 offset:3072
    ds_read_b64_tr_b16 v[42:43], v220 offset:3840
    s_waitcnt lgkmcnt(8)
    v_mfma_f32_32x32x16_bf16 v[56:71], v[24:27], v[120:123], v[56:71]
    ds_read_b64_tr_b16 v[44:45], v221 offset:3072
    ds_read_b64_tr_b16 v[46:47], v221 offset:3840
    v_mfma_f32_16x16x32_bf16 v[208:211], v[24:27], v[212:215], v[208:211]
    buffer_load_dwordx4 v8, s[20:23], s60 offen lds
    s_add_u32 m0, s46, 77824
    s_add_u32 s60, s60, 32768
    s_cmp_eq_u32 s60, 1409024
    s_cselect_b32 s60, 0, s60
    s_waitcnt lgkmcnt(8)
    v_mfma_f32_32x32x16_bf16 v[72:87], v[28:31], v[120:123], v[72:87]
    ds_read_b64_tr_b16 v[24:25], v219 offset:6144
    ds_read_b64_tr_b16 v[26:27], v219 offset:6912
    s_waitcnt vmcnt(8)
    ds_add_u32 v9, v5
    ds_read_b128 v[104:107], v50 offset:32768
    s_waitcnt lgkmcnt(10)
    v_mfma_f32_32x32x16_bf16 v[88:103], v[32:35], v[120:123], v[88:103]
    ds_read_b64_tr_b16 v[28:29], v220 offset:6144
    ds_read_b64_tr_b16 v[30:31], v220 offset:6912
    buffer_load_dwordx4 v8, s[20:23], s60 offen lds
    ds_read_b128 v[108:111], v51 offset:32768
    s_waitcnt lgkmcnt(11)
    v_mfma_f32_32x32x16_bf16 v[56:71], v[36:39], v[124:127], v[56:71]
    ds_read_b64_tr_b16 v[32:33], v221 offset:6144
    ds_read_b64_tr_b16 v[34:35], v221 offset:6912
    ds_read_b128 v[112:115], v52 offset:32768
    ds_read_b128 v[116:119], v53 offset:32768
    v_mfma_f32_16x16x32_bf16 v[208:211], v[36:39], v[212:215], v[208:211]
    s_add_u32 m0, s46, 81920
    s_add_u32 s60, s60, 32768
    s_cmp_eq_u32 s60, 1409024
    s_cselect_b32 s60, 0, s60
    buffer_load_dwordx4 v8, s[20:23], s60 offen lds
    s_waitcnt lgkmcnt(13)
    v_mfma_f32_32x32x16_bf16 v[72:87], v[40:43], v[124:127], v[72:87]
    ds_read_b64_tr_b16 v[36:37], v219 offset:9216
    ds_read_b64_tr_b16 v[38:39], v219 offset:9984
    ds_read_b32 v12, v11
    s_add_u32 m0, s46, 86016
    s_waitcnt lgkmcnt(14)
    v_mfma_f32_32x32x16_bf16 v[88:103], v[44:47], v[124:127], v[88:103]
    ds_read_b64_tr_b16 v[40:41], v220 offset:9216
    ds_read_b64_tr_b16 v[42:43], v220 offset:9984
    s_add_u32 s60, s60, 32768
    s_cmp_eq_u32 s60, 1409024
    s_cselect_b32 s60, 0, s60
    buffer_load_dwordx4 v8, s[20:23], s60 offen lds
    s_waitcnt lgkmcnt(14)
    v_mfma_f32_32x32x16_bf16 v[56:71], v[24:27], v[128:131], v[56:71]
    ds_read_b64_tr_b16 v[44:45], v221 offset:9216
    ds_read_b64_tr_b16 v[46:47], v221 offset:9984
    s_add_u32 m0, s46, 36864
    s_add_u32 s60, s60, 32768
    s_cmp_eq_u32 s60, 1409024
    s_cselect_b32 s60, 0, s60
    v_mfma_f32_16x16x32_bf16 v[208:211], v[24:27], v[212:215], v[208:211]
    buffer_load_dwordx4 v8, s[20:23], s60 offen lds
    s_waitcnt lgkmcnt(4)
    v_cmp_gt_u32 vcc, 7, v12
    v_mfma_f32_32x32x16_bf16 v[72:87], v[28:31], v[128:131], v[72:87]
    s_cbranch_vccnz PS_35
PB_36:
    ds_read_b64_tr_b16 v[24:25], v219 offset:12288
    ds_read_b64_tr_b16 v[26:27], v219 offset:13056
    s_lshl_b32 s62, s44, 1
    s_lshr_b32 s63, s3, 1
    s_add_u32 s62, s62, s63
    s_mul_i32 s63, s62, 88064
    s_add_u32 s63, s63, 13631488
    s_and_b32 s47, s3, 1
    s_lshl_b32 s47, s47, 10
    s_add_u32 s63, s63, s47
    v_add_u32 v14, s63, v15
    s_lshl_b32 s62, s62, 11
    s_add_u32 s47, s62, 22151168
    v_min_u32 v13, 14, v2
    v_lshlrev_b32 v13, 7, v13
    v_mfma_f32_32x32x16_bf16 v[88:103], v[32:35], v[128:131], v[88:103]
    ds_read_b64_tr_b16 v[28:29], v220 offset:12288
    ds_read_b64_tr_b16 v[30:31], v220 offset:13056
    s_add_u32 m0, s46, 40960
    s_add_u32 s60, s60, 32768
    s_cmp_eq_u32 s60, 1409024
    s_cselect_b32 s60, 0, s60
    buffer_load_dwordx4 v8, s[20:23], s60 offen lds
    v_mfma_f32_32x32x16_bf16 v[56:71], v[36:39], v[132:135], v[56:71]
    ds_read_b64_tr_b16 v[32:33], v221 offset:12288
    ds_read_b64_tr_b16 v[34:35], v221 offset:13056
    buffer_load_dword v255, v13, s[24:27], s47 offen sc1
    s_lshl_b32 s48, s42, 2
    s_add_u32 s48, s48, s3
    s_lshl_b32 s48, s48, 9
    s_add_u32 s48, s48, 22413312
    v_mfma_f32_16x16x32_bf16 v[208:211], v[36:39], v[212:215], v[208:211]
    s_add_u32 m0, s46, 45056
    s_add_u32 s60, s60, 32768
    s_cmp_eq_u32 s60, 1409024
    s_cselect_b32 s60, 0, s60
    buffer_load_dwordx4 v8, s[20:23], s60 offen lds
    s_waitcnt lgkmcnt(8)
    v_mfma_f32_32x32x16_bf16 v[72:87], v[40:43], v[132:135], v[72:87]
    ds_read_b64_tr_b16 v[36:37], v219 offset:15360
    ds_read_b64_tr_b16 v[38:39], v219 offset:16128
    buffer_load_dwordx4 v[228:231], v23, s[24:27], s48 offen sc1
    s_add_u32 m0, s46, 90112
    s_waitcnt lgkmcnt(8)
    v_mfma_f32_32x32x16_bf16 v[88:103], v[44:47], v[132:135], v[88:103]
    ds_read_b64_tr_b16 v[40:41], v220 offset:15360
    ds_read_b64_tr_b16 v[42:43], v220 offset:16128
    s_add_u32 s60, s60, 32768
    s_cmp_eq_u32 s60, 1409024
    s_cselect_b32 s60, 0, s60
    s_waitcnt lgkmcnt(8)
    v_mfma_f32_32x32x16_bf16 v[56:71], v[24:27], v[104:107], v[56:71]
    ds_read_b64_tr_b16 v[44:45], v221 offset:15360
    ds_read_b64_tr_b16 v[46:47], v221 offset:16128
    v_mfma_f32_16x16x32_bf16 v[208:211], v[24:27], v[212:215], v[208:211]
    buffer_load_dwordx4 v8, s[20:23], s60 offen lds
    s_add_u32 m0, s46, 94208
    s_add_u32 s60, s60, 32768
    s_cmp_eq_u32 s60, 1409024
    s_cselect_b32 s60, 0, s60
    s_waitcnt lgkmcnt(8)
    v_mfma_f32_32x32x16_bf16 v[72:87], v[28:31], v[104:107], v[72:87]
    ds_read_b64_tr_b16 v[24:25], v219 offset:18432
    ds_read_b64_tr_b16 v[26:27], v219 offset:19200
    s_waitcnt vmcnt(10)
    ds_add_u32 v9, v5
    ds_read_b128 v[120:123], v50 offset:49152
    s_waitcnt lgkmcnt(10)
    v_mfma_f32_32x32x16_bf16 v[88:103], v[32:35], v[104:107], v[88:103]
    ds_read_b64_tr_b16 v[28:29], v220 offset:18432
    ds_read_b64_tr_b16 v[30:31], v220 offset:19200
    buffer_load_dwordx4 v8, s[20:23], s60 offen lds
    ds_read_b128 v[124:127], v51 offset:49152
    s_waitcnt lgkmcnt(11)
    v_mfma_f32_32x32x16_bf16 v[56:71], v[36:39], v[108:111], v[56:71]
    ds_read_b64_tr_b16 v[32:33], v221 offset:18432
    ds_read_b64_tr_b16 v[34:35], v221 offset:19200
    ds_read_b128 v[128:131], v52 offset:49152
    ds_read_b128 v[132:135], v53 offset:49152
    v_mfma_f32_16x16x32_bf16 v[208:211], v[36:39], v[212:215], v[208:211]
    s_add_u32 m0, s46, 98304
    s_add_u32 s60, s60, 32768
    s_cmp_eq_u32 s60, 1409024
    s_cselect_b32 s60, 0, s60
    buffer_load_dwordx4 v8, s[20:23], s60 offen lds
    s_waitcnt lgkmcnt(13)
    v_mfma_f32_32x32x16_bf16 v[72:87], v[40:43], v[108:111], v[72:87]
    ds_read_b64_tr_b16 v[36:37], v219 offset:21504
    ds_read_b64_tr_b16 v[38:39], v219 offset:22272
    ds_read_b32 v12, v11
    s_add_u32 m0, s46, 102400
    s_waitcnt lgkmcnt(14)
    v_mfma_f32_32x32x16_bf16 v[88:103], v[44:47], v[108:111], v[88:103]
    ds_read_b64_tr_b16 v[40:41], v220 offset:21504
    ds_read_b64_tr_b16 v[42:43], v220 offset:22272
    s_add_u32 s60, s60, 32768
    s_cmp_eq_u32 s60, 1409024
    s_cselect_b32 s60, 0, s60
    buffer_load_dwordx4 v8, s[20:23], s60 offen lds
    s_waitcnt lgkmcnt(14)
    v_mfma_f32_32x32x16_bf16 v[56:71], v[24:27], v[112:115], v[56:71]
    ds_read_b64_tr_b16 v[44:45], v221 offset:21504
    ds_read_b64_tr_b16 v[46:47], v221 offset:22272
    s_add_u32 m0, s46, 49152
    s_add_u32 s60, s60, 32768
    s_cmp_eq_u32 s60, 1409024
    s_cselect_b32 s60, 0, s60
    v_mfma_f32_16x16x32_bf16 v[208:211], v[24:27], v[212:215], v[208:211]
    buffer_load_dwordx4 v8, s[20:23], s60 offen lds
    s_waitcnt lgkmcnt(4)
    v_cmp_gt_u32 vcc, 8, v12
    v_mfma_f32_32x32x16_bf16 v[72:87], v[28:31], v[112:115], v[72:87]
    s_cbranch_vccnz PS_37
PB_38:
    ds_read_b64_tr_b16 v[24:25], v219 offset:24576
    ds_read_b64_tr_b16 v[26:27], v219 offset:25344
    s_add_u32 m0, s46, 53248
    s_add_u32 s60, s60, 32768
    s_cmp_eq_u32 s60, 1409024
    s_cselect_b32 s60, 0, s60
    v_mfma_f32_32x32x16_bf16 v[88:103], v[32:35], v[112:115], v[88:103]
    ds_read_b64_tr_b16 v[28:29], v219 offset:27648
    ds_read_b64_tr_b16 v[30:31], v219 offset:28416
    buffer_load_dwordx4 v8, s[20:23], s60 offen lds
    s_add_u32 m0, s46, 57344
    s_add_u32 s60, s60, 32768
    s_cmp_eq_u32 s60, 1409024
    s_cselect_b32 s60, 0, s60
    v_mfma_f32_32x32x16_bf16 v[56:71], v[36:39], v[116:119], v[56:71]
    ds_read_b64_tr_b16 v[32:33], v219 offset:30720
    ds_read_b64_tr_b16 v[34:35], v219 offset:31488
    v_mfma_f32_16x16x32_bf16 v[208:211], v[36:39], v[212:215], v[208:211]
    buffer_load_dwordx4 v8, s[20:23], s60 offen lds
    s_add_u32 m0, s46, 106496
    s_add_u32 s60, s60, 32768
    s_cmp_eq_u32 s60, 1409024
    s_cselect_b32 s60, 0, s60
    s_waitcnt lgkmcnt(8)
    v_mfma_f32_32x32x16_bf16 v[72:87], v[40:43], v[116:119], v[72:87]
    ds_read_b64_tr_b16 v[36:37], v219 offset:33792
    ds_read_b64_tr_b16 v[38:39], v219 offset:34560
    s_waitcnt lgkmcnt(8)
    v_mfma_f32_32x32x16_bf16 v[88:103], v[44:47], v[116:119], v[88:103]
    ds_read_b64_tr_b16 v[40:41], v220 offset:24576
    ds_read_b64_tr_b16 v[42:43], v220 offset:25344
    s_waitcnt lgkmcnt(8)
    v_mfma_f32_32x32x16_bf16 v[56:71], v[24:27], v[120:123], v[56:71]
    ds_read_b64_tr_b16 v[44:45], v220 offset:27648
    ds_read_b64_tr_b16 v[46:47], v220 offset:28416
    v_mfma_f32_16x16x32_bf16 v[208:211], v[24:27], v[212:215], v[208:211]
    buffer_load_dwordx4 v8, s[20:23], s60 offen lds
    s_add_u32 m0, s46, 110592
    s_add_u32 s60, s60, 32768
    s_cmp_eq_u32 s60, 1409024
    s_cselect_b32 s60, 0, s60
    s_waitcnt lgkmcnt(8)
    v_mfma_f32_32x32x16_bf16 v[56:71], v[28:31], v[124:127], v[56:71]
    ds_read_b64_tr_b16 v[24:25], v220 offset:30720
    ds_read_b64_tr_b16 v[26:27], v220 offset:31488
    s_waitcnt vmcnt(6)
    ds_add_u32 v9, v5
    ds_read_b32 v12, v11
    v_mfma_f32_16x16x32_bf16 v[208:211], v[28:31], v[212:215], v[208:211]
    buffer_load_dwordx4 v8, s[20:23], s60 offen lds
    s_add_u32 m0, s46, 114688
    s_add_u32 s60, s60, 32768
    s_cmp_eq_u32 s60, 1409024
    s_cselect_b32 s60, 0, s60
    s_waitcnt lgkmcnt(10)
    v_mfma_f32_32x32x16_bf16 v[56:71], v[32:35], v[128:131], v[56:71]
    ds_read_b64_tr_b16 v[28:29], v220 offset:33792
    ds_read_b64_tr_b16 v[30:31], v220 offset:34560
    v_mfma_f32_16x16x32_bf16 v[208:211], v[32:35], v[212:215], v[208:211]
    buffer_load_dwordx4 v8, s[20:23], s60 offen lds
    s_waitcnt lgkmcnt(2)
    v_cmp_gt_u32 vcc, 9, v12
    v_mfma_f32_32x32x16_bf16 v[56:71], v[36:39], v[132:135], v[56:71]
    ds_read_b64_tr_b16 v[32:33], v221 offset:24576
    ds_read_b64_tr_b16 v[34:35], v221 offset:25344
    s_cbranch_vccnz PS_39
PB_40:
    s_add_u32 m0, s46, 118784
    s_add_u32 s60, s60, 32768
    s_cmp_eq_u32 s60, 1409024
    s_cselect_b32 s60, 0, s60
    v_mfma_f32_16x16x32_bf16 v[208:211], v[36:39], v[212:215], v[208:211]
    buffer_load_dwordx4 v8, s[20:23], s60 offen lds
    s_add_u32 m0, s46, 0
    s_add_u32 s60, s60, 32768
    s_cmp_eq_u32 s60, 1409024
    s_cselect_b32 s60, 0, s60
    v_mfma_f32_32x32x16_bf16 v[72:87], v[40:43], v[120:123], v[72:87]
    ds_read_b64_tr_b16 v[36:37], v221 offset:27648
    ds_read_b64_tr_b16 v[38:39], v221 offset:28416
    ds_read_b64_tr_b16 v[136:137], v234 offset:8192
    ds_read_b64_tr_b16 v[138:139], v234 offset:9216
    v_mfma_f32_32x32x16_bf16 v[72:87], v[44:47], v[124:127], v[72:87]
    ds_read_b64_tr_b16 v[40:41], v221 offset:30720
    ds_read_b64_tr_b16 v[42:43], v221 offset:31488
    buffer_load_dwordx4 v8, s[20:23], s60 offen lds
    s_mov_b64 exec, s[94:95]
    ds_write_b128 v55, v[208:211]
    s_mov_b64 exec, -1
    ds_add_u32 v9, v5
    v_mfma_f32_32x32x16_bf16 v[72:87], v[24:27], v[128:131], v[72:87]
    ds_read_b64_tr_b16 v[44:45], v221 offset:33792
    ds_read_b64_tr_b16 v[46:47], v221 offset:34560
    s_add_u32 m0, s46, 4096
    s_add_u32 s60, s60, 32768
    s_cmp_eq_u32 s60, 1409024
    s_cselect_b32 s60, 0, s60
    s_waitcnt lgkmcnt(12)
    v_mfma_f32_32x32x16_bf16 v[72:87], v[28:31], v[132:135], v[72:87]
    buffer_load_dwordx4 v8, s[20:23], s60 offen lds
    s_add_u32 m0, s46, 8192
    s_add_u32 s60, s60, 32768
    s_cmp_eq_u32 s60, 1409024
    s_cselect_b32 s60, 0, s60
    ds_read_b64_tr_b16 v[140:141], v235 offset:8192
    s_waitcnt lgkmcnt(11)
    v_mfma_f32_32x32x16_bf16 v[88:103], v[32:35], v[120:123], v[88:103]
    ds_read_b64_tr_b16 v[142:143], v235 offset:9216
    ds_read_b64_tr_b16 v[144:145], v234 offset:12288
    ds_read_b64_tr_b16 v[146:147], v234 offset:13312
    ds_read_b64_tr_b16 v[148:149], v235 offset:12288
    s_waitcnt lgkmcnt(13)
    v_mfma_f32_32x32x16_bf16 v[88:103], v[36:39], v[124:127], v[88:103]
    buffer_load_dwordx4 v8, s[20:23], s60 offen lds
    s_add_u32 m0, s46, 122880
    s_add_u32 s60, s60, 32768
    s_cmp_eq_u32 s60, 1409024
    s_cselect_b32 s60, 0, s60
    ds_read_b64_tr_b16 v[150:151], v235 offset:13312
    s_waitcnt lgkmcnt(10)
    v_mfma_f32_32x32x16_bf16 v[88:103], v[40:43], v[128:131], v[88:103]
    ds_read_b64_tr_b16 v[152:153], v234 offset:16384
    ds_read_b64_tr_b16 v[154:155], v234 offset:17408
    ds_read_b64_tr_b16 v[156:157], v235 offset:16384
    ds_read_b64_tr_b16 v[158:159], v235 offset:17408
    s_waitcnt lgkmcnt(10)
    v_mfma_f32_32x32x16_bf16 v[88:103], v[44:47], v[132:135], v[88:103]
    ds_read_b64_tr_b16 v[160:161], v234 offset:20480
    ds_read_b64_tr_b16 v[162:163], v234 offset:21504
    ds_read_b64_tr_b16 v[164:165], v235 offset:20480
    ds_read_b64_tr_b16 v[166:167], v235 offset:21504
    ds_read_b64_tr_b16 v[168:169], v232 offset:36864
    ds_read_b64_tr_b16 v[170:171], v232 offset:37888
    ds_read_b64_tr_b16 v[172:173], v233 offset:36864
    ds_read_b64_tr_b16 v[174:175], v233 offset:37888
    ds_read_b64_tr_b16 v[176:177], v232 offset:40960
    ds_read_b64_tr_b16 v[178:179], v232 offset:41984
    ds_read_b64_tr_b16 v[180:181], v233 offset:40960
    ds_read_b64_tr_b16 v[182:183], v233 offset:41984
    ds_read_b64_tr_b16 v[184:185], v232 offset:45056
    ds_read_b64_tr_b16 v[186:187], v232 offset:46080
    ds_read_b64_tr_b16 v[188:189], v233 offset:45056
    ds_read_b64_tr_b16 v[190:191], v233 offset:46080
    ds_read_b64_tr_b16 v[192:193], v234 offset:24576
    ds_read_b64_tr_b16 v[194:195], v234 offset:25600
    ds_read_b64_tr_b16 v[196:197], v235 offset:24576
    ds_read_b64_tr_b16 v[198:199], v235 offset:25600
    ds_read_b64_tr_b16 v[200:201], v234 offset:28672
    ds_read_b64_tr_b16 v[202:203], v234 offset:29696
    ds_read_b64_tr_b16 v[204:205], v235 offset:28672
    ds_read_b64_tr_b16 v[206:207], v235 offset:29696
    s_mov_b32 s63, 32768
PW_41:
    ds_read_b32 v12, v11
    s_waitcnt lgkmcnt(0)
    v_cmp_gt_u32 vcc, 10, v12
    s_nop 1
    s_cbranch_vccz PD_42
    s_sub_u32 s63, s63, 1
    s_cmp_lg_u32 s63, 0
    s_cbranch_scc1 PW_41
PD_42:
    ds_add_u32 v9, v5
    ds_read_b128 v[24:27], v225 offset:0
    ds_read_b128 v[28:31], v225 offset:32
    ds_read_b128 v[32:35], v225 offset:64
    ds_read_b128 v[36:39], v225 offset:96
    ds_read_b128 v[40:43], v226 offset:0
    ds_read_b128 v[44:47], v226 offset:32
    ds_read_b128 v[48:51], v226 offset:64
    ds_read_b128 v[52:55], v226 offset:96
    s_mov_b32 s63, 32768
TL_43:
    ds_read_b32 v22, v6 offset:96
    s_waitcnt lgkmcnt(0)
    v_readfirstlane_b32 s38, v22
    s_nop 0
    s_cmp_lg_u32 s38, 0
    s_cbranch_scc1 TD_44
    s_sleep 1
    s_sub_u32 s63, s63, 1
    s_cmp_lg_u32 s63, 0
    s_cbranch_scc1 TL_43
TD_44:
    v_cmp_ne_u32 s[50:51], s38, v231
    v_cmp_ne_u32 s[52:53], s38, v231
    s_nop 0
    s_or_b64 s[58:59], s[50:51], s[52:53]
    s_cmp_eq_u64 s[58:59], 0
    s_cbranch_scc1 GD_46
    s_mov_b32 s63, 32768
GL_45:
    s_mov_b64 exec, s[50:51]
    buffer_load_dwordx4 v[228:231], v23, s[24:27], s48 offen sc1
    s_mov_b64 exec, s[52:53]
    buffer_load_dwordx4 v[228:231], v23, s[24:27], s48 offen sc1
    s_waitcnt vmcnt(0)
    s_mov_b64 exec, s[50:51]
    v_cmp_ne_u32 s[50:51], s38, v231
    s_mov_b64 exec, s[52:53]
    v_cmp_ne_u32 s[52:53], s38, v231
    s_mov_b64 exec, -1
    s_or_b64 s[58:59], s[50:51], s[52:53]
    s_cmp_eq_u64 s[58:59], 0
    s_cbranch_scc1 GD_46
    s_sleep 6
    s_sub_u32 s63, s63, 1
    s_cmp_lg_u32 s63, 0
    s_cbranch_scc1 GL_45
GD_46:
    s_mov_b32 s48, 0xbfb8aa3b
    v_pk_fma_f32 v[56:57], v[24:25], v[228:229], v[56:57] op_sel_hi:[1,0,1]
    v_pk_fma_f32 v[58:59], v[26:27], v[228:229], v[58:59] op_sel_hi:[1,0,1]
    v_pk_fma_f32 v[60:61], v[28:29], v[228:229], v[60:61] op_sel_hi:[1,0,1]
    v_pk_fma_f32 v[62:63], v[30:31], v[228:229], v[62:63] op_sel_hi:[1,0,1]
    v_pk_mul_f32 v[56:57], v[56:57], v[230:231] op_sel_hi:[1,0]
    v_pk_mul_f32 v[58:59], v[58:59], v[230:231] op_sel_hi:[1,0]
    v_pk_mul_f32 v[60:61], v[60:61], v[230:231] op_sel_hi:[1,0]
    v_pk_mul_f32 v[62:63], v[62:63], v[230:231] op_sel_hi:[1,0]
    v_cvt_pk_bf16_f32 v240, v56, v57
    v_cvt_pk_bf16_f32 v241, v58, v59
    v_cvt_pk_bf16_f32 v242, v60, v61
    v_cvt_pk_bf16_f32 v243, v62, v63
    v_lshlrev_b32 v104, 16, v240
    v_and_b32 v105, s39, v240
    v_lshlrev_b32 v106, 16, v241
    v_and_b32 v107, s39, v241
    v_lshlrev_b32 v108, 16, v242
    v_and_b32 v109, s39, v242
    v_lshlrev_b32 v110, 16, v243
    v_and_b32 v111, s39, v243
    v_pk_mul_f32 v[112:113], v[104:105], s[48:49] op_sel_hi:[1,0]
    v_pk_mul_f32 v[114:115], v[106:107], s[48:49] op_sel_hi:[1,0]
    v_pk_mul_f32 v[116:117], v[108:109], s[48:49] op_sel_hi:[1,0]
    v_pk_mul_f32 v[118:119], v[110:111], s[48:49] op_sel_hi:[1,0]
    v_exp_f32 v112, v112
    v_exp_f32 v113, v113
    v_exp_f32 v114, v114
    v_exp_f32 v115, v115
    v_exp_f32 v116, v116
    v_exp_f32 v117, v117
    v_exp_f32 v118, v118
    v_exp_f32 v119, v119
    v_pk_add_f32 v[112:113], v[112:113], 1.0 op_sel_hi:[1,0]
    v_pk_add_f32 v[114:115], v[114:115], 1.0 op_sel_hi:[1,0]
    v_pk_add_f32 v[116:117], v[116:117], 1.0 op_sel_hi:[1,0]
    v_pk_add_f32 v[118:119], v[118:119], 1.0 op_sel_hi:[1,0]
    v_rcp_f32 v112, v112
    v_rcp_f32 v113, v113
    v_rcp_f32 v114, v114
    v_rcp_f32 v115, v115
    v_rcp_f32 v116, v116
    v_rcp_f32 v117, v117
    v_rcp_f32 v118, v118
    v_rcp_f32 v119, v119
    v_pk_mul_f32 v[112:113], v[112:113], v[104:105]
    v_pk_mul_f32 v[114:115], v[114:115], v[106:107]
    v_pk_mul_f32 v[116:117], v[116:117], v[108:109]
    v_pk_mul_f32 v[118:119], v[118:119], v[110:111]
    v_cvt_pk_bf16_f32 v240, v112, v113
    v_cvt_pk_bf16_f32 v241, v114, v115
    v_cvt_pk_bf16_f32 v242, v116, v117
    v_cvt_pk_bf16_f32 v243, v118, v119
    s_mov_b64 exec, s[86:87]
    buffer_store_dwordx4 v[240:243], v222, s[24:27], s57 offen offset:0 sc1
    s_mov_b64 exec, -1
    v_pk_fma_f32 v[64:65], v[32:33], v[228:229], v[64:65] op_sel_hi:[1,0,1]
    v_pk_fma_f32 v[66:67], v[34:35], v[228:229], v[66:67] op_sel_hi:[1,0,1]
    v_pk_fma_f32 v[68:69], v[36:37], v[228:229], v[68:69] op_sel_hi:[1,0,1]
    v_pk_fma_f32 v[70:71], v[38:39], v[228:229], v[70:71] op_sel_hi:[1,0,1]
    v_pk_mul_f32 v[64:65], v[64:65], v[230:231] op_sel_hi:[1,0]
    v_pk_mul_f32 v[66:67], v[66:67], v[230:231] op_sel_hi:[1,0]
    v_pk_mul_f32 v[68:69], v[68:69], v[230:231] op_sel_hi:[1,0]
    v_pk_mul_f32 v[70:71], v[70:71], v[230:231] op_sel_hi:[1,0]
    v_cvt_pk_bf16_f32 v244, v64, v65
    v_cvt_pk_bf16_f32 v245, v66, v67
    v_cvt_pk_bf16_f32 v246, v68, v69
    v_cvt_pk_bf16_f32 v247, v70, v71
    v_lshlrev_b32 v120, 16, v244
    v_and_b32 v121, s39, v244
    v_lshlrev_b32 v122, 16, v245
    v_and_b32 v123, s39, v245
    v_lshlrev_b32 v124, 16, v246
    v_and_b32 v125, s39, v246
    v_lshlrev_b32 v126, 16, v247
    v_and_b32 v127, s39, v247
    v_pk_mul_f32 v[128:129], v[120:121], s[48:49] op_sel_hi:[1,0]
    v_pk_mul_f32 v[130:131], v[122:123], s[48:49] op_sel_hi:[1,0]
    v_pk_mul_f32 v[132:133], v[124:125], s[48:49] op_sel_hi:[1,0]
    v_pk_mul_f32 v[134:135], v[126:127], s[48:49] op_sel_hi:[1,0]
    v_exp_f32 v128, v128
    v_exp_f32 v129, v129
    v_exp_f32 v130, v130
    v_exp_f32 v131, v131
    v_exp_f32 v132, v132
    v_exp_f32 v133, v133
    v_exp_f32 v134, v134
    v_exp_f32 v135, v135
    v_pk_add_f32 v[128:129], v[128:129], 1.0 op_sel_hi:[1,0]
    v_pk_add_f32 v[130:131], v[130:131], 1.0 op_sel_hi:[1,0]
    v_pk_add_f32 v[132:133], v[132:133], 1.0 op_sel_hi:[1,0]
    v_pk_add_f32 v[134:135], v[134:135], 1.0 op_sel_hi:[1,0]
    v_rcp_f32 v128, v128
    v_rcp_f32 v129, v129
    v_rcp_f32 v130, v130
    v_rcp_f32 v131, v131
    v_rcp_f32 v132, v132
    v_rcp_f32 v133, v133
    v_rcp_f32 v134, v134
    v_rcp_f32 v135, v135
    v_pk_mul_f32 v[128:129], v[128:129], v[120:121]
    v_pk_mul_f32 v[130:131], v[130:131], v[122:123]
    v_pk_mul_f32 v[132:133], v[132:133], v[124:125]
    v_pk_mul_f32 v[134:135], v[134:135], v[126:127]
    v_cvt_pk_bf16_f32 v244, v128, v129
    v_cvt_pk_bf16_f32 v245, v130, v131
    v_cvt_pk_bf16_f32 v246, v132, v133
    v_cvt_pk_bf16_f32 v247, v134, v135
    s_mov_b64 exec, s[86:87]
    buffer_store_dwordx4 v[244:247], v222, s[24:27], s57 offen offset:1024 sc1
    s_mov_b64 exec, -1
    v_pk_fma_f32 v[72:73], v[40:41], v[228:229], v[72:73] op_sel_hi:[1,0,1]
    ds_read_b128 v[24:27], v227 offset:0
    ds_read_b128 v[28:31], v227 offset:32
    ds_read_b128 v[32:35], v227 offset:64
    ds_read_b128 v[36:39], v227 offset:96
    v_pk_fma_f32 v[74:75], v[42:43], v[228:229], v[74:75] op_sel_hi:[1,0,1]
    v_pk_fma_f32 v[76:77], v[44:45], v[228:229], v[76:77] op_sel_hi:[1,0,1]
    v_pk_fma_f32 v[78:79], v[46:47], v[228:229], v[78:79] op_sel_hi:[1,0,1]
    v_pk_mul_f32 v[72:73], v[72:73], v[230:231] op_sel_hi:[1,0]
    v_pk_mul_f32 v[74:75], v[74:75], v[230:231] op_sel_hi:[1,0]
    v_pk_mul_f32 v[76:77], v[76:77], v[230:231] op_sel_hi:[1,0]
    v_pk_mul_f32 v[78:79], v[78:79], v[230:231] op_sel_hi:[1,0]
    v_cvt_pk_bf16_f32 v240, v72, v73
    v_cvt_pk_bf16_f32 v241, v74, v75
    v_cvt_pk_bf16_f32 v242, v76, v77
    v_cvt_pk_bf16_f32 v243, v78, v79
    v_lshlrev_b32 v104, 16, v240
    v_and_b32 v105, s39, v240
    v_lshlrev_b32 v106, 16, v241
    v_and_b32 v107, s39, v241
    v_lshlrev_b32 v108, 16, v242
    v_and_b32 v109, s39, v242
    v_lshlrev_b32 v110, 16, v243
    v_and_b32 v111, s39, v243
    v_pk_mul_f32 v[112:113], v[104:105], s[48:49] op_sel_hi:[1,0]
    v_pk_mul_f32 v[114:115], v[106:107], s[48:49] op_sel_hi:[1,0]
    v_pk_mul_f32 v[116:117], v[108:109], s[48:49] op_sel_hi:[1,0]
    v_pk_mul_f32 v[118:119], v[110:111], s[48:49] op_sel_hi:[1,0]
    v_exp_f32 v112, v112
    v_exp_f32 v113, v113
    v_exp_f32 v114, v114
    v_exp_f32 v115, v115
    v_exp_f32 v116, v116
    v_exp_f32 v117, v117
    v_exp_f32 v118, v118
    v_exp_f32 v119, v119
    v_pk_add_f32 v[112:113], v[112:113], 1.0 op_sel_hi:[1,0]
    v_pk_add_f32 v[114:115], v[114:115], 1.0 op_sel_hi:[1,0]
    v_pk_add_f32 v[116:117], v[116:117], 1.0 op_sel_hi:[1,0]
    v_pk_add_f32 v[118:119], v[118:119], 1.0 op_sel_hi:[1,0]
    v_rcp_f32 v112, v112
    v_rcp_f32 v113, v113
    v_rcp_f32 v114, v114
    v_rcp_f32 v115, v115
    v_rcp_f32 v116, v116
    v_rcp_f32 v117, v117
    v_rcp_f32 v118, v118
    v_rcp_f32 v119, v119
    v_pk_mul_f32 v[112:113], v[112:113], v[104:105]
    v_pk_mul_f32 v[114:115], v[114:115], v[106:107]
    v_pk_mul_f32 v[116:117], v[116:117], v[108:109]
    v_pk_mul_f32 v[118:119], v[118:119], v[110:111]
    v_cvt_pk_bf16_f32 v240, v112, v113
    v_cvt_pk_bf16_f32 v241, v114, v115
    v_cvt_pk_bf16_f32 v242, v116, v117
    v_cvt_pk_bf16_f32 v243, v118, v119
    s_mov_b64 exec, s[88:89]
    buffer_store_dwordx4 v[240:243], v223, s[24:27], s57 offen offset:0 sc1
    s_mov_b64 exec, -1
    v_pk_fma_f32 v[80:81], v[48:49], v[228:229], v[80:81] op_sel_hi:[1,0,1]
    v_pk_fma_f32 v[82:83], v[50:51], v[228:229], v[82:83] op_sel_hi:[1,0,1]
    v_pk_fma_f32 v[84:85], v[52:53], v[228:229], v[84:85] op_sel_hi:[1,0,1]
    v_pk_fma_f32 v[86:87], v[54:55], v[228:229], v[86:87] op_sel_hi:[1,0,1]
    v_pk_mul_f32 v[80:81], v[80:81], v[230:231] op_sel_hi:[1,0]
    v_pk_mul_f32 v[82:83], v[82:83], v[230:231] op_sel_hi:[1,0]
    v_pk_mul_f32 v[84:85], v[84:85], v[230:231] op_sel_hi:[1,0]
    v_pk_mul_f32 v[86:87], v[86:87], v[230:231] op_sel_hi:[1,0]
    v_cvt_pk_bf16_f32 v244, v80, v81
    v_cvt_pk_bf16_f32 v245, v82, v83
    v_cvt_pk_bf16_f32 v246, v84, v85
    v_cvt_pk_bf16_f32 v247, v86, v87
    v_lshlrev_b32 v120, 16, v244
    v_and_b32 v121, s39, v244
    v_lshlrev_b32 v122, 16, v245
    v_and_b32 v123, s39, v245
    v_lshlrev_b32 v124, 16, v246
    v_and_b32 v125, s39, v246
    v_lshlrev_b32 v126, 16, v247
    v_and_b32 v127, s39, v247
    v_pk_mul_f32 v[128:129], v[120:121], s[48:49] op_sel_hi:[1,0]
    v_pk_mul_f32 v[130:131], v[122:123], s[48:49] op_sel_hi:[1,0]
    v_pk_mul_f32 v[132:133], v[124:125], s[48:49] op_sel_hi:[1,0]
    v_pk_mul_f32 v[134:135], v[126:127], s[48:49] op_sel_hi:[1,0]
    v_exp_f32 v128, v128
    v_exp_f32 v129, v129
    v_exp_f32 v130, v130
    v_exp_f32 v131, v131
    v_exp_f32 v132, v132
    v_exp_f32 v133, v133
    v_exp_f32 v134, v134
    v_exp_f32 v135, v135
    v_pk_add_f32 v[128:129], v[128:129], 1.0 op_sel_hi:[1,0]
    v_pk_add_f32 v[130:131], v[130:131], 1.0 op_sel_hi:[1,0]
    v_pk_add_f32 v[132:133], v[132:133], 1.0 op_sel_hi:[1,0]
    v_pk_add_f32 v[134:135], v[134:135], 1.0 op_sel_hi:[1,0]
    v_rcp_f32 v128, v128
    v_rcp_f32 v129, v129
    v_rcp_f32 v130, v130
    v_rcp_f32 v131, v131
    v_rcp_f32 v132, v132
    v_rcp_f32 v133, v133
    v_rcp_f32 v134, v134
    v_rcp_f32 v135, v135
    v_pk_mul_f32 v[128:129], v[128:129], v[120:121]
    v_pk_mul_f32 v[130:131], v[130:131], v[122:123]
    v_pk_mul_f32 v[132:133], v[132:133], v[124:125]
    v_pk_mul_f32 v[134:135], v[134:135], v[126:127]
    v_cvt_pk_bf16_f32 v244, v128, v129
    v_cvt_pk_bf16_f32 v245, v130, v131
    v_cvt_pk_bf16_f32 v246, v132, v133
    v_cvt_pk_bf16_f32 v247, v134, v135
    s_mov_b64 exec, s[88:89]
    buffer_store_dwordx4 v[244:247], v223, s[24:27], s57 offen offset:1024 sc1
    s_mov_b64 exec, -1
    s_waitcnt lgkmcnt(0)
    v_pk_fma_f32 v[88:89], v[24:25], v[228:229], v[88:89] op_sel_hi:[1,0,1]
    v_pk_fma_f32 v[90:91], v[26:27], v[228:229], v[90:91] op_sel_hi:[1,0,1]
    v_pk_fma_f32 v[92:93], v[28:29], v[228:229], v[92:93] op_sel_hi:[1,0,1]
    v_pk_fma_f32 v[94:95], v[30:31], v[228:229], v[94:95] op_sel_hi:[1,0,1]
    v_pk_mul_f32 v[88:89], v[88:89], v[230:231] op_sel_hi:[1,0]
    v_pk_mul_f32 v[90:91], v[90:91], v[230:231] op_sel_hi:[1,0]
    v_pk_mul_f32 v[92:93], v[92:93], v[230:231] op_sel_hi:[1,0]
    v_pk_mul_f32 v[94:95], v[94:95], v[230:231] op_sel_hi:[1,0]
    v_cvt_pk_bf16_f32 v240, v88, v89
    v_cvt_pk_bf16_f32 v241, v90, v91
    v_cvt_pk_bf16_f32 v242, v92, v93
    v_cvt_pk_bf16_f32 v243, v94, v95
    v_lshlrev_b32 v104, 16, v240
    v_and_b32 v105, s39, v240
    v_lshlrev_b32 v106, 16, v241
    v_and_b32 v107, s39, v241
    v_lshlrev_b32 v108, 16, v242
    v_and_b32 v109, s39, v242
    v_lshlrev_b32 v110, 16, v243
    v_and_b32 v111, s39, v243
    v_pk_mul_f32 v[112:113], v[104:105], s[48:49] op_sel_hi:[1,0]
    v_pk_mul_f32 v[114:115], v[106:107], s[48:49] op_sel_hi:[1,0]
    v_pk_mul_f32 v[116:117], v[108:109], s[48:49] op_sel_hi:[1,0]
    v_pk_mul_f32 v[118:119], v[110:111], s[48:49] op_sel_hi:[1,0]
    v_exp_f32 v112, v112
    v_exp_f32 v113, v113
    v_exp_f32 v114, v114
    v_exp_f32 v115, v115
    v_exp_f32 v116, v116
    v_exp_f32 v117, v117
    v_exp_f32 v118, v118
    v_exp_f32 v119, v119
    v_pk_add_f32 v[112:113], v[112:113], 1.0 op_sel_hi:[1,0]
    v_pk_add_f32 v[114:115], v[114:115], 1.0 op_sel_hi:[1,0]
    v_pk_add_f32 v[116:117], v[116:117], 1.0 op_sel_hi:[1,0]
    v_pk_add_f32 v[118:119], v[118:119], 1.0 op_sel_hi:[1,0]
    v_rcp_f32 v112, v112
    v_rcp_f32 v113, v113
    v_rcp_f32 v114, v114
    v_rcp_f32 v115, v115
    v_rcp_f32 v116, v116
    v_rcp_f32 v117, v117
    v_rcp_f32 v118, v118
    v_rcp_f32 v119, v119
    v_pk_mul_f32 v[112:113], v[112:113], v[104:105]
    v_pk_mul_f32 v[114:115], v[114:115], v[106:107]
    v_pk_mul_f32 v[116:117], v[116:117], v[108:109]
    v_pk_mul_f32 v[118:119], v[118:119], v[110:111]
    v_cvt_pk_bf16_f32 v240, v112, v113
    v_cvt_pk_bf16_f32 v241, v114, v115
    v_cvt_pk_bf16_f32 v242, v116, v117
    v_cvt_pk_bf16_f32 v243, v118, v119
    s_mov_b64 exec, s[90:91]
    buffer_store_dwordx4 v[240:243], v224, s[24:27], s57 offen offset:0 sc1
    s_mov_b64 exec, -1
    v_pk_fma_f32 v[96:97], v[32:33], v[228:229], v[96:97] op_sel_hi:[1,0,1]
    v_pk_fma_f32 v[98:99], v[34:35], v[228:229], v[98:99] op_sel_hi:[1,0,1]
    v_pk_fma_f32 v[100:101], v[36:37], v[228:229], v[100:101] op_sel_hi:[1,0,1]
    v_pk_fma_f32 v[102:103], v[38:39], v[228:229], v[102:103] op_sel_hi:[1,0,1]
    v_pk_mul_f32 v[96:97], v[96:97], v[230:231] op_sel_hi:[1,0]
    v_pk_mul_f32 v[98:99], v[98:99], v[230:231] op_sel_hi:[1,0]
    v_pk_mul_f32 v[100:101], v[100:101], v[230:231] op_sel_hi:[1,0]
    v_pk_mul_f32 v[102:103], v[102:103], v[230:231] op_sel_hi:[1,0]
    v_cvt_pk_bf16_f32 v244, v96, v97
    v_cvt_pk_bf16_f32 v245, v98, v99
    v_cvt_pk_bf16_f32 v246, v100, v101
    v_cvt_pk_bf16_f32 v247, v102, v103
    v_lshlrev_b32 v120, 16, v244
    v_and_b32 v121, s39, v244
    v_lshlrev_b32 v122, 16, v245
    v_and_b32 v123, s39, v245
    v_lshlrev_b32 v124, 16, v246
    v_and_b32 v125, s39, v246
    v_lshlrev_b32 v126, 16, v247
    v_and_b32 v127, s39, v247
    v_pk_mul_f32 v[128:129], v[120:121], s[48:49] op_sel_hi:[1,0]
    v_pk_mul_f32 v[130:131], v[122:123], s[48:49] op_sel_hi:[1,0]
    v_pk_mul_f32 v[132:133], v[124:125], s[48:49] op_sel_hi:[1,0]
    v_pk_mul_f32 v[134:135], v[126:127], s[48:49] op_sel_hi:[1,0]
    v_exp_f32 v128, v128
    v_exp_f32 v129, v129
    v_exp_f32 v130, v130
    v_exp_f32 v131, v131
    v_exp_f32 v132, v132
    v_exp_f32 v133, v133
    v_exp_f32 v134, v134
    v_exp_f32 v135, v135
    v_pk_add_f32 v[128:129], v[128:129], 1.0 op_sel_hi:[1,0]
    v_pk_add_f32 v[130:131], v[130:131], 1.0 op_sel_hi:[1,0]
    v_pk_add_f32 v[132:133], v[132:133], 1.0 op_sel_hi:[1,0]
    v_pk_add_f32 v[134:135], v[134:135], 1.0 op_sel_hi:[1,0]
    v_rcp_f32 v128, v128
    v_rcp_f32 v129, v129
    v_rcp_f32 v130, v130
    v_rcp_f32 v131, v131
    v_rcp_f32 v132, v132
    v_rcp_f32 v133, v133
    v_rcp_f32 v134, v134
    v_rcp_f32 v135, v135
    v_pk_mul_f32 v[128:129], v[128:129], v[120:121]
    v_pk_mul_f32 v[130:131], v[130:131], v[122:123]
    v_pk_mul_f32 v[132:133], v[132:133], v[124:125]
    v_pk_mul_f32 v[134:135], v[134:135], v[126:127]
    v_cvt_pk_bf16_f32 v244, v128, v129
    v_cvt_pk_bf16_f32 v245, v130, v131
    v_cvt_pk_bf16_f32 v246, v132, v133
    v_cvt_pk_bf16_f32 v247, v134, v135
    s_mov_b64 exec, s[90:91]
    buffer_store_dwordx4 v[244:247], v224, s[24:27], s57 offen offset:1024 sc1
    s_mov_b64 exec, -1
    s_lshl_b32 s62, s44, 1
    s_lshr_b32 s63, s3, 1
    s_add_u32 s62, s62, s63
    s_mul_i32 s63, s62, 88064
    s_add_u32 s63, s63, 13631488
    s_and_b32 s47, s3, 1
    s_lshl_b32 s47, s47, 10
    s_add_u32 s63, s63, s47
    v_add_u32 v14, s63, v15
    s_lshl_b32 s62, s62, 11
    s_add_u32 s47, s62, 22151168
    v_min_u32 v13, 14, v2
    v_lshlrev_b32 v13, 7, v13
    s_waitcnt vmcnt(0)
    v_mov_b32 v18, s38
    v_mov_b32 v19, s38
    v_mov_b32 v20, s38
    v_mov_b32 v21, s38
    s_mov_b64 exec, 0xff
    buffer_store_dwordx4 v[18:21], v15, s[24:27], s56 offen sc1
    s_mov_b64 exec, -1
    buffer_load_dwordx4 v8, s[20:23], s60 offen lds
    s_add_u32 m0, s46, 126976
    s_add_u32 s60, s60, 32768
    s_cmp_eq_u32 s60, 1409024
    s_cselect_b32 s60, 0, s60
    buffer_load_dwordx4 v8, s[20:23], s60 offen lds
    s_add_u32 m0, s46, 131072
    s_add_u32 s60, s60, 32768
    s_cmp_eq_u32 s60, 1409024
    s_cselect_b32 s60, 0, s60
    buffer_load_dwordx4 v8, s[20:23], s60 offen lds
    s_add_u32 m0, s46, 135168
    s_add_u32 s60, s60, 32768
    s_cmp_eq_u32 s60, 1409024
    s_cselect_b32 s60, 0, s60
    buffer_load_dwordx4 v8, s[20:23], s60 offen lds
    s_add_u32 m0, s46, 12288
    s_add_u32 s60, s60, 32768
    s_cmp_eq_u32 s60, 1409024
    s_cselect_b32 s60, 0, s60
    buffer_load_dwordx4 v8, s[20:23], s60 offen lds
    s_add_u32 m0, s46, 16384
    s_add_u32 s60, s60, 32768
    s_cmp_eq_u32 s60, 1409024
    s_cselect_b32 s60, 0, s60
    buffer_load_dwordx4 v8, s[20:23], s60 offen lds
    s_add_u32 m0, s46, 20480
    s_add_u32 s60, s60, 32768
    s_cmp_eq_u32 s60, 1409024
    s_cselect_b32 s60, 0, s60
    buffer_load_dwordx4 v8, s[20:23], s60 offen lds
    s_mov_b32 s63, 32768
PW_47:
    ds_read_b32 v12, v11
    s_waitcnt lgkmcnt(0)
    v_cmp_gt_u32 vcc, 11, v12
    s_nop 1
    s_cbranch_vccz PD_48
    s_sub_u32 s63, s63, 1
    s_cmp_lg_u32 s63, 0
    s_cbranch_scc1 PW_47
PD_48:
    s_mov_b32 s63, 32768
BW_49:
    ds_read_b32 v22, v6 offset:52
    s_waitcnt lgkmcnt(0)
    v_readfirstlane_b32 s62, v22
    s_nop 0
    s_cmp_ge_u32 s62, 4
    s_cbranch_scc1 BD_50
    s_sub_u32 s63, s63, 1
    s_cmp_lg_u32 s63, 0
    s_cbranch_scc1 BW_49
BD_50:
    s_add_u32 m0, s46, 24576
    s_add_u32 s60, s60, 32768
    s_cmp_eq_u32 s60, 1409024
    s_cselect_b32 s60, 0, s60
    buffer_load_dwordx4 v8, s[20:23], s60 offen lds
    s_add_u32 m0, s46, 28672
    s_add_u32 s60, s60, 32768
    s_cmp_eq_u32 s60, 1409024
    s_cselect_b32 s60, 0, s60
    buffer_load_dwordx4 v8, s[20:23], s60 offen lds
    s_add_u32 m0, s46, 32768
    s_add_u32 s60, s60, 32768
    s_cmp_eq_u32 s60, 1409024
    s_cselect_b32 s60, 0, s60
    buffer_load_dwordx4 v8, s[20:23], s60 offen lds
    s_add_u32 m0, s46, 61440
    s_add_u32 s60, s60, 32768
    s_cmp_eq_u32 s60, 1409024
    s_cselect_b32 s60, 0, s60
    buffer_load_dwordx4 v8, s[20:23], s60 offen lds
    s_add_u32 m0, s46, 65536
    s_add_u32 s60, s60, 32768
    s_cmp_eq_u32 s60, 1409024
    s_cselect_b32 s60, 0, s60
    buffer_load_dwordx4 v8, s[20:23], s60 offen lds
    s_add_u32 m0, s46, 69632
    s_add_u32 s60, s60, 32768
    s_cmp_eq_u32 s60, 1409024
    s_cselect_b32 s60, 0, s60
    buffer_load_dwordx4 v8, s[20:23], s60 offen lds
    s_add_u32 m0, s46, 73728
    s_add_u32 s60, s60, 32768
    s_cmp_eq_u32 s60, 1409024
    s_cselect_b32 s60, 0, s60
    buffer_load_dwordx4 v8, s[20:23], s60 offen lds
    s_add_u32 m0, s46, 77824
    s_add_u32 s60, s60, 32768
    s_cmp_eq_u32 s60, 1409024
    s_cselect_b32 s60, 0, s60
    buffer_load_dwordx4 v8, s[20:23], s60 offen lds
    s_add_u32 m0, s46, 81920
    s_add_u32 s60, s60, 32768
    s_cmp_eq_u32 s60, 1409024
    s_cselect_b32 s60, 0, s60
    buffer_load_dwordx4 v8, s[20:23], s60 offen lds
    s_add_u32 m0, s46, 86016
    s_add_u32 s60, s60, 32768
    s_cmp_eq_u32 s60, 1409024
    s_cselect_b32 s60, 0, s60
    buffer_load_dwordx4 v8, s[20:23], s60 offen lds
    s_add_u32 m0, s46, 36864
    s_add_u32 s60, s60, 32768
    s_cmp_eq_u32 s60, 1409024
    s_cselect_b32 s60, 0, s60
    buffer_load_dwordx4 v8, s[20:23], s60 offen lds
    s_add_u32 m0, s46, 40960
    s_add_u32 s60, s60, 32768
    s_cmp_eq_u32 s60, 1409024
    s_cselect_b32 s60, 0, s60
    buffer_load_dwordx4 v8, s[20:23], s60 offen lds
    s_add_u32 m0, s46, 45056
    s_add_u32 s60, s60, 32768
    s_cmp_eq_u32 s60, 1409024
    s_cselect_b32 s60, 0, s60
    buffer_load_dwordx4 v8, s[20:23], s60 offen lds
    s_add_u32 m0, s46, 90112
    s_add_u32 s60, s60, 32768
    s_cmp_eq_u32 s60, 1409024
    s_cselect_b32 s60, 0, s60
    buffer_load_dwordx4 v8, s[20:23], s60 offen lds
    s_add_u32 m0, s46, 94208
    s_add_u32 s60, s60, 32768
    s_cmp_eq_u32 s60, 1409024
    s_cselect_b32 s60, 0, s60
    buffer_load_dwordx4 v8, s[20:23], s60 offen lds
    s_branch G2_PRO
PS_25:
    s_mov_b32 s63, 32768
PW_51:
    ds_read_b32 v12, v11
    s_waitcnt lgkmcnt(0)
    v_cmp_gt_u32 vcc, 2, v12
    s_nop 1
    s_cbranch_vccz PD_52
    s_sub_u32 s63, s63, 1
    s_cmp_lg_u32 s63, 0
    s_cbranch_scc1 PW_51
PD_52:
    s_branch PB_26
PS_27:
    s_mov_b32 s63, 32768
PW_53:
    ds_read_b32 v12, v11
    s_waitcnt lgkmcnt(0)
    v_cmp_gt_u32 vcc, 3, v12
    s_nop 1
    s_cbranch_vccz PD_54
    s_sub_u32 s63, s63, 1
    s_cmp_lg_u32 s63, 0
    s_cbranch_scc1 PW_53
PD_54:
    s_branch PB_28
PS_29:
    s_mov_b32 s63, 32768
PW_55:
    ds_read_b32 v12, v11
    s_waitcnt lgkmcnt(0)
    v_cmp_gt_u32 vcc, 4, v12
    s_nop 1
    s_cbranch_vccz PD_56
    s_sub_u32 s63, s63, 1
    s_cmp_lg_u32 s63, 0
    s_cbranch_scc1 PW_55
PD_56:
    s_branch PB_30
PS_31:
    s_mov_b32 s63, 32768
PW_57:
    ds_read_b32 v12, v11
    s_waitcnt lgkmcnt(0)
    v_cmp_gt_u32 vcc, 5, v12
    s_nop 1
    s_cbranch_vccz PD_58
    s_sub_u32 s63, s63, 1
    s_cmp_lg_u32 s63, 0
    s_cbranch_scc1 PW_57
PD_58:
    s_branch PB_32
PS_33:
    s_mov_b32 s63, 32768
PW_59:
    ds_read_b32 v12, v11
    s_waitcnt lgkmcnt(0)
    v_cmp_gt_u32 vcc, 6, v12
    s_nop 1
    s_cbranch_vccz PD_60
    s_sub_u32 s63, s63, 1
    s_cmp_lg_u32 s63, 0
    s_cbranch_scc1 PW_59
PD_60:
    s_branch PB_34
PS_35:
    s_mov_b32 s63, 32768
PW_61:
    ds_read_b32 v12, v11
    s_waitcnt lgkmcnt(0)
    v_cmp_gt_u32 vcc, 7, v12
    s_nop 1
    s_cbranch_vccz PD_62
    s_sub_u32 s63, s63, 1
    s_cmp_lg_u32 s63, 0
    s_cbranch_scc1 PW_61
PD_62:
    s_branch PB_36
PS_37:
    s_mov_b32 s63, 32768
PW_63:
    ds_read_b32 v12, v11
    s_waitcnt lgkmcnt(0)
    v_cmp_gt_u32 vcc, 8, v12
    s_nop 1
    s_cbranch_vccz PD_64
    s_sub_u32 s63, s63, 1
    s_cmp_lg_u32 s63, 0
    s_cbranch_scc1 PW_63
PD_64:
    s_branch PB_38
PS_39:
    s_mov_b32 s63, 32768
PW_65:
    ds_read_b32 v12, v11
    s_waitcnt lgkmcnt(0)
    v_cmp_gt_u32 vcc, 9, v12
    s_nop 1
    s_cbranch_vccz PD_66
    s_sub_u32 s63, s63, 1
    s_cmp_lg_u32 s63, 0
    s_cbranch_scc1 PW_65
PD_66:
    s_branch PB_40
G_IDLE:
    s_and_b32 s48, s37, 3
    s_mul_i32 s41, s45, 43
    s_lshr_b32 s41, s41, 3
    s_mul_i32 s48, s48, 11
    s_add_u32 s41, s41, s48
    s_cmp_ge_u32 s41, 43
    s_cselect_b32 s48, 43, 0
    s_sub_u32 s41, s41, s48
    s_mul_i32 s48, s36, 5
    s_add_u32 s41, s41, s48
    s_cmp_ge_u32 s41, 43
    s_cselect_b32 s48, 43, 0
    s_sub_u32 s41, s41, s48
    s_mul_i32 s41, s41, 1024
    s_lshl_b32 s48, s3, 2
    s_add_u32 s48, s48, 162048
    v_mov_b32 v17, s48
    v_lshrrev_b32 v18, 3, v1
    v_bfe_u32 v19, v1, 4, 1
    v_lshlrev_b32 v19, 2, v19
    v_and_b32 v20, 7, v1
    v_xor_b32 v20, v20, v19
    v_lshlrev_b32 v18, 10, v18
    v_lshl_add_u32 v8, v20, 4, v18
    s_lshl_b32 s48, s3, 13
    s_lshl_b32 s49, s45, 7
    s_add_u32 s48, s48, s49
    v_add_u32 v8, s48, v8
    s_cmp_eq_u32 s2, 255
    s_cbranch_scc1 G_COL
    s_add_u32 m0, s46, 73728
    s_lshl_b32 s60, s41, 5
    buffer_load_dwordx4 v8, s[20:23], s60 offen lds
    s_add_u32 m0, s46, 77824
    s_add_u32 s60, s60, 32768
    s_cmp_eq_u32 s60, 1409024
    s_cselect_b32 s60, 0, s60
    buffer_load_dwordx4 v8, s[20:23], s60 offen lds
    s_add_u32 m0, s46, 81920
    s_add_u32 s60, s60, 32768
    s_cmp_eq_u32 s60, 1409024
    s_cselect_b32 s60, 0, s60
    buffer_load_dwordx4 v8, s[20:23], s60 offen lds
    s_add_u32 m0, s46, 86016
    s_add_u32 s60, s60, 32768
    s_cmp_eq_u32 s60, 1409024
    s_cselect_b32 s60, 0, s60
    buffer_load_dwordx4 v8, s[20:23], s60 offen lds
    s_add_u32 m0, s46, 36864
    s_add_u32 s60, s60, 32768
    s_cmp_eq_u32 s60, 1409024
    s_cselect_b32 s60, 0, s60
    buffer_load_dwordx4 v8, s[20:23], s60 offen lds
    s_add_u32 m0, s46, 40960
    s_add_u32 s60, s60, 32768
    s_cmp_eq_u32 s60, 1409024
    s_cselect_b32 s60, 0, s60
    buffer_load_dwordx4 v8, s[20:23], s60 offen lds
    s_add_u32 m0, s46, 45056
    s_add_u32 s60, s60, 32768
    s_cmp_eq_u32 s60, 1409024
    s_cselect_b32 s60, 0, s60
    buffer_load_dwordx4 v8, s[20:23], s60 offen lds
    s_add_u32 m0, s46, 90112
    s_add_u32 s60, s60, 32768
    s_cmp_eq_u32 s60, 1409024
    s_cselect_b32 s60, 0, s60
    buffer_load_dwordx4 v8, s[20:23], s60 offen lds
    s_add_u32 m0, s46, 94208
    s_add_u32 s60, s60, 32768
    s_cmp_eq_u32 s60, 1409024
    s_cselect_b32 s60, 0, s60
    buffer_load_dwordx4 v8, s[20:23], s60 offen lds
    s_waitcnt vmcnt(8)
    s_add_u32 m0, s46, 98304
    s_add_u32 s60, s60, 32768
    s_cmp_eq_u32 s60, 1409024
    s_cselect_b32 s60, 0, s60
    buffer_load_dwordx4 v8, s[20:23], s60 offen lds
    s_waitcnt vmcnt(8)
    s_add_u32 m0, s46, 102400
    s_add_u32 s60, s60, 32768
    s_cmp_eq_u32 s60, 1409024
    s_cselect_b32 s60, 0, s60
    buffer_load_dwordx4 v8, s[20:23], s60 offen lds
    s_waitcnt vmcnt(8)
    s_add_u32 m0, s46, 49152
    s_add_u32 s60, s60, 32768
    s_cmp_eq_u32 s60, 1409024
    s_cselect_b32 s60, 0, s60
    buffer_load_dwordx4 v8, s[20:23], s60 offen lds
    s_branch G_IDLE2
G_COL:
    s_add_u32 m0, s46, 73728
    s_lshl_b32 s60, s41, 5
    buffer_load_dwordx4 v8, s[20:23], s60 offen lds
    s_add_u32 m0, s46, 77824
    s_add_u32 s60, s60, 32768
    s_cmp_eq_u32 s60, 1409024
    s_cselect_b32 s60, 0, s60
    buffer_load_dwordx4 v8, s[20:23], s60 offen lds
    s_add_u32 m0, s46, 81920
    s_add_u32 s60, s60, 32768
    s_cmp_eq_u32 s60, 1409024
    s_cselect_b32 s60, 0, s60
    buffer_load_dwordx4 v8, s[20:23], s60 offen lds
    s_add_u32 m0, s46, 86016
    s_add_u32 s60, s60, 32768
    s_cmp_eq_u32 s60, 1409024
    s_cselect_b32 s60, 0, s60
    buffer_load_dwordx4 v8, s[20:23], s60 offen lds
    s_add_u32 m0, s46, 36864
    s_add_u32 s60, s60, 32768
    s_cmp_eq_u32 s60, 1409024
    s_cselect_b32 s60, 0, s60
    buffer_load_dwordx4 v8, s[20:23], s60 offen lds
    s_add_u32 m0, s46, 40960
    s_add_u32 s60, s60, 32768
    s_cmp_eq_u32 s60, 1409024
    s_cselect_b32 s60, 0, s60
    buffer_load_dwordx4 v8, s[20:23], s60 offen lds
    s_add_u32 m0, s46, 45056
    s_add_u32 s60, s60, 32768
    s_cmp_eq_u32 s60, 1409024
    s_cselect_b32 s60, 0, s60
    buffer_load_dwordx4 v8, s[20:23], s60 offen lds
    s_add_u32 m0, s46, 90112
    s_add_u32 s60, s60, 32768
    s_cmp_eq_u32 s60, 1409024
    s_cselect_b32 s60, 0, s60
    buffer_load_dwordx4 v8, s[20:23], s60 offen lds
    s_add_u32 m0, s46, 94208
    s_add_u32 s60, s60, 32768
    s_cmp_eq_u32 s60, 1409024
    s_cselect_b32 s60, 0, s60
    buffer_load_dwordx4 v8, s[20:23], s60 offen lds
    s_waitcnt vmcnt(8)
    s_add_u32 m0, s46, 98304
    s_add_u32 s60, s60, 32768
    s_cmp_eq_u32 s60, 1409024
    s_cselect_b32 s60, 0, s60
    buffer_load_dwordx4 v8, s[20:23], s60 offen lds
    s_waitcnt vmcnt(8)
    s_add_u32 m0, s46, 102400
    s_add_u32 s60, s60, 32768
    s_cmp_eq_u32 s60, 1409024
    s_cselect_b32 s60, 0, s60
    buffer_load_dwordx4 v8, s[20:23], s60 offen lds
    s_waitcnt vmcnt(8)
    s_add_u32 m0, s46, 49152
    s_add_u32 s60, s60, 32768
    s_cmp_eq_u32 s60, 1409024
    s_cselect_b32 s60, 0, s60
    buffer_load_dwordx4 v8, s[20:23], s60 offen lds
    s_mov_b32 s63, 32768
TL_67:
    ds_read_b32 v22, v6 offset:96
    s_waitcnt lgkmcnt(0)
    v_readfirstlane_b32 s38, v22
    s_nop 0
    s_cmp_lg_u32 s38, 0
    s_cbranch_scc1 TD_68
    s_sleep 1
    s_sub_u32 s63, s63, 1
    s_cmp_lg_u32 s63, 0
    s_cbranch_scc1 TL_67
TD_68:
    s_setprio 3
    v_mov_b32 v13, s60
    s_mov_b32 s60, 256
    s_mov_b32 s41, 0
    v_add_u32 v6, 32, v6
    s_branch CFC_START
    s_nop 1
G_CFRET:
    s_setprio 0
    s_mov_b32 s63, 32768
BW_69:
    ds_read_b32 v22, v6 offset:12
    s_waitcnt lgkmcnt(0)
    v_readfirstlane_b32 s62, v22
    s_nop 0
    s_cmp_ge_u32 s62, 4
    s_cbranch_scc1 BD_70
    s_sub_u32 s63, s63, 1
    s_cmp_lg_u32 s63, 0
    s_cbranch_scc1 BW_69
BD_70:
    v_subrev_u32 v6, 32, v6
    s_waitcnt vmcnt(0) lgkmcnt(0)
    s_lshr_b32 s42, s36, 1
    s_lshl_b32 s42, s42, 2
    s_and_b32 s48, s37, 3
    s_add_u32 s42, s42, s48
    s_and_b32 s43, s36, 1
    s_lshl_b32 s43, s43, 3
    s_lshr_b32 s45, s37, 2
    s_add_u32 s43, s43, s45
    s_lshl_b32 s44, s36, 2
    s_add_u32 s44, s44, s48
    s_lshl_b32 s46, s3, 10
    v_lshlrev_b32 v15, 4, v1
    s_and_b32 s48, s37, 3
    s_mul_i32 s41, s45, 43
    s_lshr_b32 s41, s41, 3
    s_mul_i32 s48, s48, 11
    s_add_u32 s41, s41, s48
    s_cmp_ge_u32 s41, 43
    s_cselect_b32 s48, 43, 0
    s_sub_u32 s41, s41, s48
    s_mul_i32 s48, s36, 5
    s_add_u32 s41, s41, s48
    s_cmp_ge_u32 s41, 43
    s_cselect_b32 s48, 43, 0
    s_sub_u32 s41, s41, s48
    s_mul_i32 s41, s41, 1024
    s_lshl_b32 s48, s3, 2
    s_add_u32 s48, s48, 162048
    v_mov_b32 v17, s48
    v_lshrrev_b32 v18, 3, v1
    v_bfe_u32 v19, v1, 4, 1
    v_lshlrev_b32 v19, 2, v19
    v_and_b32 v20, 7, v1
    v_xor_b32 v20, v20, v19
    v_lshlrev_b32 v18, 10, v18
    v_lshl_add_u32 v8, v20, 4, v18
    s_lshl_b32 s48, s3, 13
    s_lshl_b32 s49, s45, 7
    s_add_u32 s48, s48, s49
    v_add_u32 v8, s48, v8
    v_readfirstlane_b32 s60, v13
    v_mov_b32 v22, 1
    s_mov_b64 exec, 1
    ds_write_b32 v17, v22 offset:80
    s_mov_b64 exec, -1
    s_mov_b32 s63, 32768
EW_71:
    ds_read_b128 v[18:21], v6 offset:80
    s_waitcnt lgkmcnt(0)
    v_min3_u32 v18, v18, v19, v20
    v_min_u32 v18, v18, v21
    s_nop 0
    v_readfirstlane_b32 s62, v18
    s_nop 0
    s_cmp_ge_u32 s62, 1
    s_cbranch_scc1 ED_72
    s_sub_u32 s63, s63, 1
    s_cmp_lg_u32 s63, 0
    s_cbranch_scc1 EW_71
ED_72:
G_IDLE2:
    s_add_u32 m0, s46, 53248
    s_add_u32 s60, s60, 32768
    s_cmp_eq_u32 s60, 1409024
    s_cselect_b32 s60, 0, s60
    buffer_load_dwordx4 v8, s[20:23], s60 offen lds
    s_add_u32 m0, s46, 57344
    s_add_u32 s60, s60, 32768
    s_cmp_eq_u32 s60, 1409024
    s_cselect_b32 s60, 0, s60
    buffer_load_dwordx4 v8, s[20:23], s60 offen lds
    s_add_u32 m0, s46, 106496
    s_add_u32 s60, s60, 32768
    s_cmp_eq_u32 s60, 1409024
    s_cselect_b32 s60, 0, s60
    buffer_load_dwordx4 v8, s[20:23], s60 offen lds
    s_add_u32 m0, s46, 110592
    s_add_u32 s60, s60, 32768
    s_cmp_eq_u32 s60, 1409024
    s_cselect_b32 s60, 0, s60
    buffer_load_dwordx4 v8, s[20:23], s60 offen lds
    s_add_u32 m0, s46, 114688
    s_add_u32 s60, s60, 32768
    s_cmp_eq_u32 s60, 1409024
    s_cselect_b32 s60, 0, s60
    buffer_load_dwordx4 v8, s[20:23], s60 offen lds
    s_add_u32 m0, s46, 118784
    s_add_u32 s60, s60, 32768
    s_cmp_eq_u32 s60, 1409024
    s_cselect_b32 s60, 0, s60
    buffer_load_dwordx4 v8, s[20:23], s60 offen lds
    s_add_u32 m0, s46, 0
    s_add_u32 s60, s60, 32768
    s_cmp_eq_u32 s60, 1409024
    s_cselect_b32 s60, 0, s60
    buffer_load_dwordx4 v8, s[20:23], s60 offen lds
    s_add_u32 m0, s46, 4096
    s_add_u32 s60, s60, 32768
    s_cmp_eq_u32 s60, 1409024
    s_cselect_b32 s60, 0, s60
    buffer_load_dwordx4 v8, s[20:23], s60 offen lds
    s_add_u32 m0, s46, 8192
    s_add_u32 s60, s60, 32768
    s_cmp_eq_u32 s60, 1409024
    s_cselect_b32 s60, 0, s60
    buffer_load_dwordx4 v8, s[20:23], s60 offen lds
    s_waitcnt vmcnt(8)
    s_add_u32 m0, s46, 122880
    s_add_u32 s60, s60, 32768
    s_cmp_eq_u32 s60, 1409024
    s_cselect_b32 s60, 0, s60
    buffer_load_dwordx4 v8, s[20:23], s60 offen lds
    s_waitcnt vmcnt(8)
    s_add_u32 m0, s46, 126976
    s_add_u32 s60, s60, 32768
    s_cmp_eq_u32 s60, 1409024
    s_cselect_b32 s60, 0, s60
    buffer_load_dwordx4 v8, s[20:23], s60 offen lds
    s_waitcnt vmcnt(8)
    s_add_u32 m0, s46, 131072
    s_add_u32 s60, s60, 32768
    s_cmp_eq_u32 s60, 1409024
    s_cselect_b32 s60, 0, s60
    buffer_load_dwordx4 v8, s[20:23], s60 offen lds
    s_waitcnt vmcnt(8)
    s_add_u32 m0, s46, 135168
    s_add_u32 s60, s60, 32768
    s_cmp_eq_u32 s60, 1409024
    s_cselect_b32 s60, 0, s60
    buffer_load_dwordx4 v8, s[20:23], s60 offen lds
    s_waitcnt vmcnt(8)
    s_add_u32 m0, s46, 12288
    s_add_u32 s60, s60, 32768
    s_cmp_eq_u32 s60, 1409024
    s_cselect_b32 s60, 0, s60
    buffer_load_dwordx4 v8, s[20:23], s60 offen lds
    s_waitcnt vmcnt(8)
    s_add_u32 m0, s46, 16384
    s_add_u32 s60, s60, 32768
    s_cmp_eq_u32 s60, 1409024
    s_cselect_b32 s60, 0, s60
    buffer_load_dwordx4 v8, s[20:23], s60 offen lds
    s_waitcnt vmcnt(8)
    s_add_u32 m0, s46, 20480
    s_add_u32 s60, s60, 32768
    s_cmp_eq_u32 s60, 1409024
    s_cselect_b32 s60, 0, s60
    buffer_load_dwordx4 v8, s[20:23], s60 offen lds
    v_lshrrev_b32 v18, 2, v2
    v_lshrrev_b32 v19, 1, v3
    v_lshl_add_u32 v18, v19, 2, v18
    v_lshlrev_b32 v18, 7, v18
    v_and_b32 v19, 3, v2
    v_lshl_add_u32 v18, v19, 3, v18
    v_and_b32 v19, 1, v3
    v_lshl_add_u32 v18, v19, 5, v18
    v_lshrrev_b32 v19, 3, v2
    v_lshl_add_u32 v18, v19, 6, v18
    s_and_b32 s62, s3, 1
    s_lshl_b32 s62, s62, 11
    v_add_u32 v232, s62, v18
    v_xor_b32 v233, 64, v232
    v_add_u32 v234, 0x10000, v232
    v_add_u32 v236, 0x20000, v232
    v_add_u32 v235, 0x10000, v233
    v_add_u32 v237, 0x20000, v233
    s_lshl_b32 s62, s44, 1
    s_lshr_b32 s63, s3, 1
    s_add_u32 s62, s62, s63
    s_mul_i32 s63, s62, 88064
    s_add_u32 s63, s63, 13631488
    s_and_b32 s47, s3, 1
    s_lshl_b32 s47, s47, 10
    s_add_u32 s63, s63, s47
    v_add_u32 v14, s63, v15
    s_lshl_b32 s62, s62, 11
    s_add_u32 s47, s62, 22151168
    v_min_u32 v13, 14, v2
    v_lshlrev_b32 v13, 7, v13
    s_mov_b32 s63, 32768
    s_nop 1
TL_73:
    ds_read_b32 v22, v6 offset:96
    s_waitcnt lgkmcnt(0)
    v_readfirstlane_b32 s38, v22
    s_nop 0
    s_cmp_lg_u32 s38, 0
    s_cbranch_scc1 TD_74
    s_sleep 1
    s_sub_u32 s63, s63, 1
    s_cmp_lg_u32 s63, 0
    s_cbranch_scc1 TL_73
TD_74:
    s_mov_b32 s63, 32768
BW_75:
    ds_read_b32 v22, v6 offset:52
    s_waitcnt lgkmcnt(0)
    v_readfirstlane_b32 s62, v22
    s_nop 0
    s_cmp_ge_u32 s62, 4
    s_cbranch_scc1 BD_76
    s_sub_u32 s63, s63, 1
    s_cmp_lg_u32 s63, 0
    s_cbranch_scc1 BW_75
BD_76:
    s_add_u32 m0, s46, 24576
    s_add_u32 s60, s60, 32768
    s_cmp_eq_u32 s60, 1409024
    s_cselect_b32 s60, 0, s60
    buffer_load_dwordx4 v8, s[20:23], s60 offen lds
    s_add_u32 m0, s46, 28672
    s_add_u32 s60, s60, 32768
    s_cmp_eq_u32 s60, 1409024
    s_cselect_b32 s60, 0, s60
    buffer_load_dwordx4 v8, s[20:23], s60 offen lds
    s_add_u32 m0, s46, 32768
    s_add_u32 s60, s60, 32768
    s_cmp_eq_u32 s60, 1409024
    s_cselect_b32 s60, 0, s60
    buffer_load_dwordx4 v8, s[20:23], s60 offen lds
    s_add_u32 m0, s46, 61440
    s_add_u32 s60, s60, 32768
    s_cmp_eq_u32 s60, 1409024
    s_cselect_b32 s60, 0, s60
    buffer_load_dwordx4 v8, s[20:23], s60 offen lds
    s_add_u32 m0, s46, 65536
    s_add_u32 s60, s60, 32768
    s_cmp_eq_u32 s60, 1409024
    s_cselect_b32 s60, 0, s60
    buffer_load_dwordx4 v8, s[20:23], s60 offen lds
    s_add_u32 m0, s46, 69632
    s_add_u32 s60, s60, 32768
    s_cmp_eq_u32 s60, 1409024
    s_cselect_b32 s60, 0, s60
    buffer_load_dwordx4 v8, s[20:23], s60 offen lds
    s_waitcnt vmcnt(0)
    v_mov_b32 v22, 9
    s_mov_b64 exec, 1
    ds_write_b32 v17, v22 offset:64
    s_mov_b64 exec, -1
    s_mov_b32 s63, 32768
EW_77:
    ds_read_b128 v[18:21], v6 offset:64
    s_waitcnt lgkmcnt(0)
    v_min3_u32 v18, v18, v19, v20
    v_min_u32 v18, v18, v21
    s_nop 0
    v_readfirstlane_b32 s62, v18
    s_nop 0
    s_cmp_ge_u32 s62, 9
    s_cbranch_scc1 ED_78
    s_sub_u32 s63, s63, 1
    s_cmp_lg_u32 s63, 0
    s_cbranch_scc1 EW_77
ED_78:
    ds_read_b64_tr_b16 v[136:137], v234 offset:8192
    ds_read_b64_tr_b16 v[138:139], v234 offset:9216
    ds_read_b64_tr_b16 v[140:141], v235 offset:8192
    ds_read_b64_tr_b16 v[142:143], v235 offset:9216
    ds_read_b64_tr_b16 v[144:145], v234 offset:12288
    ds_read_b64_tr_b16 v[146:147], v234 offset:13312
    ds_read_b64_tr_b16 v[148:149], v235 offset:12288
    ds_read_b64_tr_b16 v[150:151], v235 offset:13312
    ds_read_b64_tr_b16 v[152:153], v234 offset:16384
    ds_read_b64_tr_b16 v[154:155], v234 offset:17408
    ds_read_b64_tr_b16 v[156:157], v235 offset:16384
    ds_read_b64_tr_b16 v[158:159], v235 offset:17408
    ds_read_b64_tr_b16 v[160:161], v234 offset:20480
    ds_read_b64_tr_b16 v[162:163], v234 offset:21504
    ds_read_b64_tr_b16 v[164:165], v235 offset:20480
    ds_read_b64_tr_b16 v[166:167], v235 offset:21504
    ds_read_b64_tr_b16 v[168:169], v232 offset:36864
    ds_read_b64_tr_b16 v[170:171], v232 offset:37888
    ds_read_b64_tr_b16 v[172:173], v233 offset:36864
    ds_read_b64_tr_b16 v[174:175], v233 offset:37888
    ds_read_b64_tr_b16 v[176:177], v232 offset:40960
    ds_read_b64_tr_b16 v[178:179], v232 offset:41984
    ds_read_b64_tr_b16 v[180:181], v233 offset:40960
    ds_read_b64_tr_b16 v[182:183], v233 offset:41984
    ds_read_b64_tr_b16 v[184:185], v232 offset:45056
    ds_read_b64_tr_b16 v[186:187], v232 offset:46080
    ds_read_b64_tr_b16 v[188:189], v233 offset:45056
    ds_read_b64_tr_b16 v[190:191], v233 offset:46080
    ds_read_b64_tr_b16 v[192:193], v234 offset:24576
    ds_read_b64_tr_b16 v[194:195], v234 offset:25600
    ds_read_b64_tr_b16 v[196:197], v235 offset:24576
    ds_read_b64_tr_b16 v[198:199], v235 offset:25600
    ds_read_b64_tr_b16 v[200:201], v234 offset:28672
    ds_read_b64_tr_b16 v[202:203], v234 offset:29696
    ds_read_b64_tr_b16 v[204:205], v235 offset:28672
    ds_read_b64_tr_b16 v[206:207], v235 offset:29696
    s_waitcnt lgkmcnt(0)
    v_mov_b32 v22, 9
    s_mov_b64 exec, 1
    ds_write_b32 v17, v22 offset:80
    s_mov_b64 exec, -1
    s_mov_b32 s63, 32768
EW_79:
    ds_read_b128 v[18:21], v6 offset:80
    s_waitcnt lgkmcnt(0)
    v_min3_u32 v18, v18, v19, v20
    v_min_u32 v18, v18, v21
    s_nop 0
    v_readfirstlane_b32 s62, v18
    s_nop 0
    s_cmp_ge_u32 s62, 9
    s_cbranch_scc1 ED_80
    s_sub_u32 s63, s63, 1
    s_cmp_lg_u32 s63, 0
    s_cbranch_scc1 EW_79
ED_80:
    s_add_u32 m0, s46, 73728
    s_add_u32 s60, s60, 32768
    s_cmp_eq_u32 s60, 1409024
    s_cselect_b32 s60, 0, s60
    buffer_load_dwordx4 v8, s[20:23], s60 offen lds
    s_add_u32 m0, s46, 77824
    s_add_u32 s60, s60, 32768
    s_cmp_eq_u32 s60, 1409024
    s_cselect_b32 s60, 0, s60
    buffer_load_dwordx4 v8, s[20:23], s60 offen lds
    s_add_u32 m0, s46, 81920
    s_add_u32 s60, s60, 32768
    s_cmp_eq_u32 s60, 1409024
    s_cselect_b32 s60, 0, s60
    buffer_load_dwordx4 v8, s[20:23], s60 offen lds
    s_add_u32 m0, s46, 86016
    s_add_u32 s60, s60, 32768
    s_cmp_eq_u32 s60, 1409024
    s_cselect_b32 s60, 0, s60
    buffer_load_dwordx4 v8, s[20:23], s60 offen lds
    s_add_u32 m0, s46, 36864
    s_add_u32 s60, s60, 32768
    s_cmp_eq_u32 s60, 1409024
    s_cselect_b32 s60, 0, s60
    buffer_load_dwordx4 v8, s[20:23], s60 offen lds
    s_add_u32 m0, s46, 40960
    s_add_u32 s60, s60, 32768
    s_cmp_eq_u32 s60, 1409024
    s_cselect_b32 s60, 0, s60
    buffer_load_dwordx4 v8, s[20:23], s60 offen lds
    s_add_u32 m0, s46, 45056
    s_add_u32 s60, s60, 32768
    s_cmp_eq_u32 s60, 1409024
    s_cselect_b32 s60, 0, s60
    buffer_load_dwordx4 v8, s[20:23], s60 offen lds
    s_add_u32 m0, s46, 90112
    s_add_u32 s60, s60, 32768
    s_cmp_eq_u32 s60, 1409024
    s_cselect_b32 s60, 0, s60
    buffer_load_dwordx4 v8, s[20:23], s60 offen lds
    s_add_u32 m0, s46, 94208
    s_add_u32 s60, s60, 32768
    s_cmp_eq_u32 s60, 1409024
    s_cselect_b32 s60, 0, s60
    buffer_load_dwordx4 v8, s[20:23], s60 offen lds
G2_PRO:
    s_lshl_b32 s48, s44, 1
    s_lshr_b32 s49, s3, 1
    s_add_u32 s48, s48, s49
    s_lshl_b32 s49, s45, 1
    s_and_b32 s55, s3, 1
    s_add_u32 s55, s55, s49
    s_mul_i32 s53, s48, 49152
    s_mul_i32 s49, s55, 1536
    s_add_u32 s53, s53, s49
    s_add_u32 s53, s53, 24117248
    s_mov_b32 s52, s38
    s_lshr_b32 s54, s48, 2
    s_lshl_b32 s54, s54, 17
    s_and_b32 s49, s48, 3
    s_lshl_b32 s49, s49, 12
    s_add_u32 s54, s54, s49
    s_lshl_b32 s49, s55, 6
    s_add_u32 s54, s54, s49
    v_and_b32 v18, 1, v3
    v_lshrrev_b32 v19, 1, v3
    v_mul_u32_u24 v20, 24576, v18
    v_lshl_add_u32 v20, v19, 8, v20
    v_lshl_add_u32 v9, v2, 4, v20
    v_add_u32 v10, 512, v9
    v_add_u32 v220, 1024, v9
    v_lshlrev_b32 v18, 11, v18
    v_lshl_add_u32 v18, v19, 4, v18
    v_and_b32 v19, 3, v2
    v_lshl_add_u32 v18, v19, 15, v18
    v_bfe_u32 v19, v2, 2, 1
    v_lshl_add_u32 v18, v19, 14, v18
    v_lshrrev_b32 v19, 3, v2
    v_lshl_add_u32 v7, v19, 10, v18
    s_lshl_b32 s49, s3, 12
    s_add_u32 s49, s49, 106496
    v_add_u32 v11, s49, v15
    v_xor_b32 v12, 4096, v11
    s_mov_b32 s63, 32768
    s_nop 1
FW_81:
    buffer_load_dword v22, v13, s[24:27], s47 offen sc1
    s_waitcnt vmcnt(0)
    v_cmp_ne_u32 vcc, s38, v22
    s_nop 4
    s_cbranch_vccz FD_82
    s_sleep 1
    s_sub_u32 s63, s63, 1
    s_cmp_lg_u32 s63, 0
    s_cbranch_scc1 FW_81
FD_82:
    v_mov_b32 v22, 10
    s_mov_b64 exec, 1
    ds_write_b32 v17, v22 offset:64
    s_mov_b64 exec, -1
    s_lshl_b32 s59, s41, 1
    buffer_load_dwordx4 v[24:27], v14, s[24:27], s59 offen
    s_add_u32 s59, s59, 2048
    s_cmp_eq_u32 s59, 88064
    s_cselect_b32 s59, 0, s59
    buffer_load_dwordx4 v[28:31], v14, s[24:27], s59 offen
    s_add_u32 s59, s59, 2048
    s_cmp_eq_u32 s59, 88064
    s_cselect_b32 s59, 0, s59
    buffer_load_dwordx4 v[32:35], v14, s[24:27], s59 offen
    s_add_u32 s59, s59, 2048
    s_cmp_eq_u32 s59, 88064
    s_cselect_b32 s59, 0, s59
    buffer_load_dwordx4 v[36:39], v14, s[24:27], s59 offen
    s_add_u32 s59, s59, 2048
    s_cmp_eq_u32 s59, 88064
    s_cselect_b32 s59, 0, s59
    buffer_load_dwordx4 v[40:43], v14, s[24:27], s59 offen
    s_add_u32 s59, s59, 2048
    s_cmp_eq_u32 s59, 88064
    s_cselect_b32 s59, 0, s59
    buffer_load_dwordx4 v[44:47], v14, s[24:27], s59 offen
    s_add_u32 s59, s59, 2048
    s_cmp_eq_u32 s59, 88064
    s_cselect_b32 s59, 0, s59
    buffer_load_dwordx4 v[48:51], v14, s[24:27], s59 offen
    s_add_u32 s59, s59, 2048
    s_cmp_eq_u32 s59, 88064
    s_cselect_b32 s59, 0, s59
    buffer_load_dwordx4 v[52:55], v14, s[24:27], s59 offen
    s_add_u32 s59, s59, 2048
    s_cmp_eq_u32 s59, 88064
    s_cselect_b32 s59, 0, s59
    buffer_load_dwordx4 v[56:59], v14, s[24:27], s59 offen
    s_add_u32 s59, s59, 2048
    s_cmp_eq_u32 s59, 88064
    s_cselect_b32 s59, 0, s59
    buffer_load_dwordx4 v[60:63], v14, s[24:27], s59 offen
    s_add_u32 s59, s59, 2048
    s_cmp_eq_u32 s59, 88064
    s_cselect_b32 s59, 0, s59
    buffer_load_dwordx4 v[76:79], v14, s[24:27], s59 offen
    s_mov_b32 s63, 32768
EW_83:
    ds_read_b128 v[18:21], v6 offset:64
    s_waitcnt lgkmcnt(0)
    v_min3_u32 v18, v18, v19, v20
    v_min_u32 v18, v18, v21
    s_nop 0
    v_readfirstlane_b32 s62, v18
    s_nop 0
    s_cmp_ge_u32 s62, 10
    s_cbranch_scc1 ED_84
    s_sub_u32 s63, s63, 1
    s_cmp_lg_u32 s63, 0
    s_cbranch_scc1 EW_83
ED_84:
    s_waitcnt vmcnt(10)
    v_mfma_f32_32x32x16_bf16 v[104:119], v[136:139], v[24:27], 0
    s_add_u32 s59, s59, 2048
    s_cmp_eq_u32 s59, 88064
    s_cselect_b32 s59, 0, s59
    v_mfma_f32_32x32x16_bf16 v[120:135], v[140:143], v[24:27], 0
    buffer_load_dwordx4 v[96:99], v14, s[24:27], s59 offen
    s_waitcnt vmcnt(10)
    v_mfma_f32_32x32x16_bf16 v[104:119], v[144:147], v[28:31], v[104:119]
    ds_read_b64_tr_b16 v[136:137], v234 offset:32768
    ds_read_b64_tr_b16 v[138:139], v234 offset:33792
    s_add_u32 s59, s59, 2048
    s_cmp_eq_u32 s59, 88064
    s_cselect_b32 s59, 0, s59
    v_mfma_f32_32x32x16_bf16 v[120:135], v[148:151], v[28:31], v[120:135]
    ds_read_b64_tr_b16 v[140:141], v235 offset:32768
    ds_read_b64_tr_b16 v[142:143], v235 offset:33792
    buffer_load_dwordx4 v[100:103], v14, s[24:27], s59 offen
    s_waitcnt vmcnt(10)
    v_mfma_f32_32x32x16_bf16 v[104:119], v[152:155], v[32:35], v[104:119]
    ds_read_b64_tr_b16 v[144:145], v234 offset:36864
    ds_read_b64_tr_b16 v[146:147], v234 offset:37888
    s_add_u32 s59, s59, 2048
    s_cmp_eq_u32 s59, 88064
    s_cselect_b32 s59, 0, s59
    v_mfma_f32_32x32x16_bf16 v[120:135], v[156:159], v[32:35], v[120:135]
    ds_read_b64_tr_b16 v[148:149], v235 offset:36864
    ds_read_b64_tr_b16 v[150:151], v235 offset:37888
    buffer_load_dwordx4 v[24:27], v14, s[24:27], s59 offen
    s_waitcnt vmcnt(10)
    v_mfma_f32_32x32x16_bf16 v[104:119], v[160:163], v[36:39], v[104:119]
    ds_read_b64_tr_b16 v[152:153], v232 offset:49152
    ds_read_b64_tr_b16 v[154:155], v232 offset:50176
    s_add_u32 s59, s59, 2048
    s_cmp_eq_u32 s59, 88064
    s_cselect_b32 s59, 0, s59
    v_mfma_f32_32x32x16_bf16 v[120:135], v[164:167], v[36:39], v[120:135]
    ds_read_b64_tr_b16 v[156:157], v233 offset:49152
    ds_read_b64_tr_b16 v[158:159], v233 offset:50176
    buffer_load_dwordx4 v[28:31], v14, s[24:27], s59 offen
    s_waitcnt vmcnt(10)
    v_mfma_f32_32x32x16_bf16 v[104:119], v[168:171], v[40:43], v[104:119]
    ds_read_b64_tr_b16 v[160:161], v232 offset:53248
    ds_read_b64_tr_b16 v[162:163], v232 offset:54272
    s_add_u32 s59, s59, 2048
    s_cmp_eq_u32 s59, 88064
    s_cselect_b32 s59, 0, s59
    v_mfma_f32_32x32x16_bf16 v[120:135], v[172:175], v[40:43], v[120:135]
    ds_read_b64_tr_b16 v[164:165], v233 offset:53248
    ds_read_b64_tr_b16 v[166:167], v233 offset:54272
    buffer_load_dwordx4 v[32:35], v14, s[24:27], s59 offen
    s_waitcnt vmcnt(10)
    v_mfma_f32_32x32x16_bf16 v[104:119], v[176:179], v[44:47], v[104:119]
    ds_read_b64_tr_b16 v[168:169], v232 offset:57344
    ds_read_b64_tr_b16 v[170:171], v232 offset:58368
    s_add_u32 s59, s59, 2048
    s_cmp_eq_u32 s59, 88064
    s_cselect_b32 s59, 0, s59
    v_mfma_f32_32x32x16_bf16 v[120:135], v[180:183], v[44:47], v[120:135]
    ds_read_b64_tr_b16 v[172:173], v233 offset:57344
    ds_read_b64_tr_b16 v[174:175], v233 offset:58368
    buffer_load_dwordx4 v[36:39], v14, s[24:27], s59 offen
    s_waitcnt vmcnt(10)
    v_mfma_f32_32x32x16_bf16 v[104:119], v[184:187], v[48:51], v[104:119]
    ds_read_b64_tr_b16 v[176:177], v234 offset:40960
    ds_read_b64_tr_b16 v[178:179], v234 offset:41984
    s_add_u32 s59, s59, 2048
    s_cmp_eq_u32 s59, 88064
    s_cselect_b32 s59, 0, s59
    v_mfma_f32_32x32x16_bf16 v[120:135], v[188:191], v[48:51], v[120:135]
    ds_read_b64_tr_b16 v[180:181], v235 offset:40960
    ds_read_b64_tr_b16 v[182:183], v235 offset:41984
    buffer_load_dwordx4 v[40:43], v14, s[24:27], s59 offen
    s_waitcnt vmcnt(10)
    v_mfma_f32_32x32x16_bf16 v[104:119], v[192:195], v[52:55], v[104:119]
    ds_read_b64_tr_b16 v[184:185], v234 offset:45056
    ds_read_b64_tr_b16 v[186:187], v234 offset:46080
    s_add_u32 s59, s59, 2048
    s_cmp_eq_u32 s59, 88064
    s_cselect_b32 s59, 0, s59
    v_mfma_f32_32x32x16_bf16 v[120:135], v[196:199], v[52:55], v[120:135]
    ds_read_b64_tr_b16 v[188:189], v235 offset:45056
    ds_read_b64_tr_b16 v[190:191], v235 offset:46080
    buffer_load_dwordx4 v[44:47], v14, s[24:27], s59 offen
    s_waitcnt vmcnt(10)
    v_mfma_f32_32x32x16_bf16 v[104:119], v[200:203], v[56:59], v[104:119]
    ds_read_b64_tr_b16 v[192:193], v234 offset:49152
    ds_read_b64_tr_b16 v[194:195], v234 offset:50176
    s_add_u32 s59, s59, 2048
    s_cmp_eq_u32 s59, 88064
    s_cselect_b32 s59, 0, s59
    v_mfma_f32_32x32x16_bf16 v[120:135], v[204:207], v[56:59], v[120:135]
    ds_read_b64_tr_b16 v[196:197], v235 offset:49152
    ds_read_b64_tr_b16 v[198:199], v235 offset:50176
    buffer_load_dwordx4 v[48:51], v14, s[24:27], s59 offen
    s_waitcnt lgkmcnt(15)
    s_waitcnt vmcnt(10)
    v_mfma_f32_32x32x16_bf16 v[104:119], v[136:139], v[60:63], v[104:119]
    ds_read_b64_tr_b16 v[200:201], v234 offset:53248
    ds_read_b64_tr_b16 v[202:203], v234 offset:54272
    s_add_u32 s59, s59, 2048
    s_cmp_eq_u32 s59, 88064
    s_cselect_b32 s59, 0, s59
    v_mfma_f32_32x32x16_bf16 v[120:135], v[140:143], v[60:63], v[120:135]
    ds_read_b64_tr_b16 v[204:205], v235 offset:53248
    ds_read_b64_tr_b16 v[206:207], v235 offset:54272
    buffer_load_dwordx4 v[52:55], v14, s[24:27], s59 offen
    s_waitcnt vmcnt(10)
    v_mfma_f32_32x32x16_bf16 v[104:119], v[144:147], v[76:79], v[104:119]
    ds_read_b64_tr_b16 v[136:137], v232 offset:0
    ds_read_b64_tr_b16 v[138:139], v232 offset:1024
    s_add_u32 s59, s59, 2048
    s_cmp_eq_u32 s59, 88064
    s_cselect_b32 s59, 0, s59
    v_mfma_f32_32x32x16_bf16 v[120:135], v[148:151], v[76:79], v[120:135]
    ds_read_b64_tr_b16 v[140:141], v233 offset:0
    ds_read_b64_tr_b16 v[142:143], v233 offset:1024
    buffer_load_dwordx4 v[56:59], v14, s[24:27], s59 offen
    s_waitcnt vmcnt(10)
    v_mfma_f32_32x32x16_bf16 v[104:119], v[152:155], v[96:99], v[104:119]
    ds_read_b64_tr_b16 v[144:145], v232 offset:4096
    ds_read_b64_tr_b16 v[146:147], v232 offset:5120
    s_add_u32 s59, s59, 2048
    s_cmp_eq_u32 s59, 88064
    s_cselect_b32 s59, 0, s59
    v_mfma_f32_32x32x16_bf16 v[120:135], v[156:159], v[96:99], v[120:135]
    ds_read_b64_tr_b16 v[148:149], v233 offset:4096
    ds_read_b64_tr_b16 v[150:151], v233 offset:5120
    buffer_load_dwordx4 v[60:63], v14, s[24:27], s59 offen
    s_waitcnt vmcnt(10)
    v_mfma_f32_32x32x16_bf16 v[104:119], v[160:163], v[100:103], v[104:119]
    ds_read_b64_tr_b16 v[152:153], v232 offset:8192
    ds_read_b64_tr_b16 v[154:155], v232 offset:9216
    s_add_u32 s59, s59, 2048
    s_cmp_eq_u32 s59, 88064
    s_cselect_b32 s59, 0, s59
    v_mfma_f32_32x32x16_bf16 v[120:135], v[164:167], v[100:103], v[120:135]
    ds_read_b64_tr_b16 v[156:157], v233 offset:8192
    ds_read_b64_tr_b16 v[158:159], v233 offset:9216
    buffer_load_dwordx4 v[76:79], v14, s[24:27], s59 offen
    s_waitcnt lgkmcnt(15)
    s_waitcnt vmcnt(10)
    v_mfma_f32_32x32x16_bf16 v[104:119], v[168:171], v[24:27], v[104:119]
    ds_read_b64_tr_b16 v[160:161], v234 offset:57344
    ds_read_b64_tr_b16 v[162:163], v234 offset:58368
    s_add_u32 s59, s59, 2048
    s_cmp_eq_u32 s59, 88064
    s_cselect_b32 s59, 0, s59
    v_mfma_f32_32x32x16_bf16 v[120:135], v[172:175], v[24:27], v[120:135]
    ds_read_b64_tr_b16 v[164:165], v235 offset:57344
    ds_read_b64_tr_b16 v[166:167], v235 offset:58368
    buffer_load_dwordx4 v[96:99], v14, s[24:27], s59 offen
    s_waitcnt vmcnt(10)
    v_mfma_f32_32x32x16_bf16 v[104:119], v[176:179], v[28:31], v[104:119]
    ds_read_b64_tr_b16 v[168:169], v234 offset:61440
    ds_read_b64_tr_b16 v[170:171], v234 offset:62464
    s_add_u32 s59, s59, 2048
    s_cmp_eq_u32 s59, 88064
    s_cselect_b32 s59, 0, s59
    v_mfma_f32_32x32x16_bf16 v[120:135], v[180:183], v[28:31], v[120:135]
    ds_read_b64_tr_b16 v[172:173], v235 offset:61440
    ds_read_b64_tr_b16 v[174:175], v235 offset:62464
    buffer_load_dwordx4 v[100:103], v14, s[24:27], s59 offen
    s_waitcnt vmcnt(10)
    v_mfma_f32_32x32x16_bf16 v[104:119], v[184:187], v[32:35], v[104:119]
    ds_read_b64_tr_b16 v[176:177], v236 offset:0
    ds_read_b64_tr_b16 v[178:179], v236 offset:1024
    s_add_u32 s59, s59, 2048
    s_cmp_eq_u32 s59, 88064
    s_cselect_b32 s59, 0, s59
    v_mfma_f32_32x32x16_bf16 v[120:135], v[188:191], v[32:35], v[120:135]
    ds_read_b64_tr_b16 v[180:181], v237 offset:0
    ds_read_b64_tr_b16 v[182:183], v237 offset:1024
    buffer_load_dwordx4 v[24:27], v14, s[24:27], s59 offen
    s_waitcnt vmcnt(10)
    v_mfma_f32_32x32x16_bf16 v[104:119], v[192:195], v[36:39], v[104:119]
    ds_read_b64_tr_b16 v[184:185], v236 offset:4096
    ds_read_b64_tr_b16 v[186:187], v236 offset:5120
    s_add_u32 s59, s59, 2048
    s_cmp_eq_u32 s59, 88064
    s_cselect_b32 s59, 0, s59
    v_mfma_f32_32x32x16_bf16 v[120:135], v[196:199], v[36:39], v[120:135]
    ds_read_b64_tr_b16 v[188:189], v237 offset:4096
    ds_read_b64_tr_b16 v[190:191], v237 offset:5120
    buffer_load_dwordx4 v[28:31], v14, s[24:27], s59 offen
    s_waitcnt lgkmcnt(15)
    s_waitcnt vmcnt(10)
    v_mfma_f32_32x32x16_bf16 v[104:119], v[200:203], v[40:43], v[104:119]
    ds_read_b64_tr_b16 v[192:193], v232 offset:12288
    ds_read_b64_tr_b16 v[194:195], v232 offset:13312
    s_add_u32 s59, s59, 2048
    s_cmp_eq_u32 s59, 88064
    s_cselect_b32 s59, 0, s59
    v_mfma_f32_32x32x16_bf16 v[120:135], v[204:207], v[40:43], v[120:135]
    ds_read_b64_tr_b16 v[196:197], v233 offset:12288
    ds_read_b64_tr_b16 v[198:199], v233 offset:13312
    buffer_load_dwordx4 v[32:35], v14, s[24:27], s59 offen
    s_waitcnt vmcnt(10)
    v_mfma_f32_32x32x16_bf16 v[104:119], v[136:139], v[44:47], v[104:119]
    ds_read_b64_tr_b16 v[200:201], v232 offset:16384
    ds_read_b64_tr_b16 v[202:203], v232 offset:17408
    s_add_u32 s59, s59, 2048
    s_cmp_eq_u32 s59, 88064
    s_cselect_b32 s59, 0, s59
    v_mfma_f32_32x32x16_bf16 v[120:135], v[140:143], v[44:47], v[120:135]
    ds_read_b64_tr_b16 v[204:205], v233 offset:16384
    ds_read_b64_tr_b16 v[206:207], v233 offset:17408
    buffer_load_dwordx4 v[36:39], v14, s[24:27], s59 offen
    s_waitcnt vmcnt(10)
    v_mfma_f32_32x32x16_bf16 v[104:119], v[144:147], v[48:51], v[104:119]
    ds_read_b64_tr_b16 v[136:137], v232 offset:20480
    ds_read_b64_tr_b16 v[138:139], v232 offset:21504
    s_add_u32 s59, s59, 2048
    s_cmp_eq_u32 s59, 88064
    s_cselect_b32 s59, 0, s59
    v_mfma_f32_32x32x16_bf16 v[120:135], v[148:151], v[48:51], v[120:135]
    ds_read_b64_tr_b16 v[140:141], v233 offset:20480
    ds_read_b64_tr_b16 v[142:143], v233 offset:21504
    buffer_load_dwordx4 v[40:43], v14, s[24:27], s59 offen
    s_waitcnt vmcnt(10)
    v_mfma_f32_32x32x16_bf16 v[104:119], v[152:155], v[52:55], v[104:119]
    ds_read_b64_tr_b16 v[144:145], v232 offset:24576
    ds_read_b64_tr_b16 v[146:147], v232 offset:25600
    s_add_u32 s59, s59, 2048
    s_cmp_eq_u32 s59, 88064
    s_cselect_b32 s59, 0, s59
    v_mov_b32 v22, 10
    s_mov_b64 exec, 1
    ds_write_b32 v17, v22 offset:80
    s_mov_b64 exec, -1
    v_mfma_f32_32x32x16_bf16 v[120:135], v[156:159], v[52:55], v[120:135]
    ds_read_b64_tr_b16 v[148:149], v233 offset:24576
    ds_read_b64_tr_b16 v[150:151], v233 offset:25600
    buffer_load_dwordx4 v[44:47], v14, s[24:27], s59 offen
    s_waitcnt lgkmcnt(15)
    s_waitcnt vmcnt(10)
    v_mfma_f32_32x32x16_bf16 v[104:119], v[160:163], v[56:59], v[104:119]
    ds_read_b64_tr_b16 v[152:153], v232 offset:28672
    ds_read_b64_tr_b16 v[154:155], v232 offset:29696
    s_add_u32 s59, s59, 2048
    s_cmp_eq_u32 s59, 88064
    s_cselect_b32 s59, 0, s59
    v_mfma_f32_32x32x16_bf16 v[120:135], v[164:167], v[56:59], v[120:135]
    ds_read_b64_tr_b16 v[156:157], v233 offset:28672
    ds_read_b64_tr_b16 v[158:159], v233 offset:29696
    buffer_load_dwordx4 v[48:51], v14, s[24:27], s59 offen
    s_waitcnt vmcnt(10)
    v_mfma_f32_32x32x16_bf16 v[104:119], v[168:171], v[60:63], v[104:119]
    ds_read_b64_tr_b16 v[160:161], v232 offset:32768
    ds_read_b64_tr_b16 v[162:163], v232 offset:33792
    s_add_u32 s59, s59, 2048
    s_cmp_eq_u32 s59, 88064
    s_cselect_b32 s59, 0, s59
    v_mfma_f32_32x32x16_bf16 v[120:135], v[172:175], v[60:63], v[120:135]
    ds_read_b64_tr_b16 v[164:165], v233 offset:32768
    ds_read_b64_tr_b16 v[166:167], v233 offset:33792
    buffer_load_dwordx4 v[52:55], v14, s[24:27], s59 offen
    s_waitcnt vmcnt(10)
    v_mfma_f32_32x32x16_bf16 v[104:119], v[176:179], v[76:79], v[104:119]
    ds_read_b64_tr_b16 v[168:169], v232 offset:61440
    ds_read_b64_tr_b16 v[170:171], v232 offset:62464
    s_add_u32 s59, s59, 2048
    s_cmp_eq_u32 s59, 88064
    s_cselect_b32 s59, 0, s59
    v_mfma_f32_32x32x16_bf16 v[120:135], v[180:183], v[76:79], v[120:135]
    ds_read_b64_tr_b16 v[172:173], v233 offset:61440
    ds_read_b64_tr_b16 v[174:175], v233 offset:62464
    buffer_load_dwordx4 v[56:59], v14, s[24:27], s59 offen
    s_waitcnt vmcnt(10)
    v_mfma_f32_32x32x16_bf16 v[104:119], v[184:187], v[96:99], v[104:119]
    ds_read_b64_tr_b16 v[176:177], v234 offset:0
    ds_read_b64_tr_b16 v[178:179], v234 offset:1024
    s_add_u32 s59, s59, 2048
    s_cmp_eq_u32 s59, 88064
    s_cselect_b32 s59, 0, s59
    v_mfma_f32_32x32x16_bf16 v[120:135], v[188:191], v[96:99], v[120:135]
    ds_read_b64_tr_b16 v[180:181], v235 offset:0
    ds_read_b64_tr_b16 v[182:183], v235 offset:1024
    buffer_load_dwordx4 v[60:63], v14, s[24:27], s59 offen
    s_waitcnt lgkmcnt(15)
    s_waitcnt vmcnt(10)
    v_mfma_f32_32x32x16_bf16 v[104:119], v[192:195], v[100:103], v[104:119]
    ds_read_b64_tr_b16 v[184:185], v234 offset:4096
    ds_read_b64_tr_b16 v[186:187], v234 offset:5120
    s_add_u32 s59, s59, 2048
    s_cmp_eq_u32 s59, 88064
    s_cselect_b32 s59, 0, s59
    v_mfma_f32_32x32x16_bf16 v[120:135], v[196:199], v[100:103], v[120:135]
    ds_read_b64_tr_b16 v[188:189], v235 offset:4096
    ds_read_b64_tr_b16 v[190:191], v235 offset:5120
    buffer_load_dwordx4 v[76:79], v14, s[24:27], s59 offen
    s_waitcnt vmcnt(10)
    v_mfma_f32_32x32x16_bf16 v[104:119], v[200:203], v[24:27], v[104:119]
    ds_read_b64_tr_b16 v[192:193], v234 offset:8192
    ds_read_b64_tr_b16 v[194:195], v234 offset:9216
    s_add_u32 s59, s59, 2048
    s_cmp_eq_u32 s59, 88064
    s_cselect_b32 s59, 0, s59
    v_mfma_f32_32x32x16_bf16 v[120:135], v[204:207], v[24:27], v[120:135]
    ds_read_b64_tr_b16 v[196:197], v235 offset:8192
    ds_read_b64_tr_b16 v[198:199], v235 offset:9216
    buffer_load_dwordx4 v[96:99], v14, s[24:27], s59 offen
    s_waitcnt vmcnt(10)
    v_mfma_f32_32x32x16_bf16 v[104:119], v[136:139], v[28:31], v[104:119]
    ds_read_b64_tr_b16 v[200:201], v234 offset:12288
    ds_read_b64_tr_b16 v[202:203], v234 offset:13312
    s_add_u32 s59, s59, 2048
    s_cmp_eq_u32 s59, 88064
    s_cselect_b32 s59, 0, s59
    v_mfma_f32_32x32x16_bf16 v[120:135], v[140:143], v[28:31], v[120:135]
    ds_read_b64_tr_b16 v[204:205], v235 offset:12288
    ds_read_b64_tr_b16 v[206:207], v235 offset:13312
    buffer_load_dwordx4 v[100:103], v14, s[24:27], s59 offen
    s_waitcnt vmcnt(10)
    v_mfma_f32_32x32x16_bf16 v[104:119], v[144:147], v[32:35], v[104:119]
    ds_read_b64_tr_b16 v[136:137], v234 offset:16384
    ds_read_b64_tr_b16 v[138:139], v234 offset:17408
    s_add_u32 s59, s59, 2048
    s_cmp_eq_u32 s59, 88064
    s_cselect_b32 s59, 0, s59
    v_mfma_f32_32x32x16_bf16 v[120:135], v[148:151], v[32:35], v[120:135]
    ds_read_b64_tr_b16 v[140:141], v235 offset:16384
    ds_read_b64_tr_b16 v[142:143], v235 offset:17408
    buffer_load_dwordx4 v[24:27], v14, s[24:27], s59 offen
    s_waitcnt lgkmcnt(15)
    s_waitcnt vmcnt(10)
    v_mfma_f32_32x32x16_bf16 v[104:119], v[152:155], v[36:39], v[104:119]
    ds_read_b64_tr_b16 v[144:145], v234 offset:20480
    ds_read_b64_tr_b16 v[146:147], v234 offset:21504
    s_add_u32 s59, s59, 2048
    s_cmp_eq_u32 s59, 88064
    s_cselect_b32 s59, 0, s59
    v_mfma_f32_32x32x16_bf16 v[120:135], v[156:159], v[36:39], v[120:135]
    ds_read_b64_tr_b16 v[148:149], v235 offset:20480
    ds_read_b64_tr_b16 v[150:151], v235 offset:21504
    buffer_load_dwordx4 v[28:31], v14, s[24:27], s59 offen
    s_waitcnt vmcnt(10)
    v_mfma_f32_32x32x16_bf16 v[104:119], v[160:163], v[40:43], v[104:119]
    ds_read_b64_tr_b16 v[152:153], v232 offset:36864
    ds_read_b64_tr_b16 v[154:155], v232 offset:37888
    s_add_u32 s59, s59, 2048
    s_cmp_eq_u32 s59, 88064
    s_cselect_b32 s59, 0, s59
    v_mfma_f32_32x32x16_bf16 v[120:135], v[164:167], v[40:43], v[120:135]
    ds_read_b64_tr_b16 v[156:157], v233 offset:36864
    ds_read_b64_tr_b16 v[158:159], v233 offset:37888
    buffer_load_dwordx4 v[32:35], v14, s[24:27], s59 offen
    s_waitcnt vmcnt(10)
    v_mfma_f32_32x32x16_bf16 v[104:119], v[168:171], v[44:47], v[104:119]
    ds_read_b64_tr_b16 v[160:161], v232 offset:40960
    ds_read_b64_tr_b16 v[162:163], v232 offset:41984
    s_add_u32 s59, s59, 2048
    s_cmp_eq_u32 s59, 88064
    s_cselect_b32 s59, 0, s59
    v_mfma_f32_32x32x16_bf16 v[120:135], v[172:175], v[44:47], v[120:135]
    ds_read_b64_tr_b16 v[164:165], v233 offset:40960
    ds_read_b64_tr_b16 v[166:167], v233 offset:41984
    buffer_load_dwordx4 v[36:39], v14, s[24:27], s59 offen
    s_waitcnt vmcnt(10)
    v_mfma_f32_32x32x16_bf16 v[104:119], v[176:179], v[48:51], v[104:119]
    ds_read_b64_tr_b16 v[168:169], v232 offset:45056
    ds_read_b64_tr_b16 v[170:171], v232 offset:46080
    v_mfma_f32_32x32x16_bf16 v[120:135], v[180:183], v[48:51], v[120:135]
    ds_read_b64_tr_b16 v[172:173], v233 offset:45056
    ds_read_b64_tr_b16 v[174:175], v233 offset:46080
    s_waitcnt lgkmcnt(15)
    s_waitcnt vmcnt(9)
    v_mfma_f32_32x32x16_bf16 v[104:119], v[184:187], v[52:55], v[104:119]
    ds_read_b64_tr_b16 v[176:177], v234 offset:24576
    ds_read_b64_tr_b16 v[178:179], v234 offset:25600
    v_mfma_f32_32x32x16_bf16 v[120:135], v[188:191], v[52:55], v[120:135]
    ds_read_b64_tr_b16 v[180:181], v235 offset:24576
    ds_read_b64_tr_b16 v[182:183], v235 offset:25600
    s_waitcnt vmcnt(8)
    v_mfma_f32_32x32x16_bf16 v[104:119], v[192:195], v[56:59], v[104:119]
    ds_read_b64_tr_b16 v[184:185], v234 offset:28672
    ds_read_b64_tr_b16 v[186:187], v234 offset:29696
    v_mfma_f32_32x32x16_bf16 v[120:135], v[196:199], v[56:59], v[120:135]
    ds_read_b64_tr_b16 v[188:189], v235 offset:28672
    ds_read_b64_tr_b16 v[190:191], v235 offset:29696
    s_waitcnt vmcnt(7)
    v_mfma_f32_32x32x16_bf16 v[104:119], v[200:203], v[60:63], v[104:119]
    v_mfma_f32_32x32x16_bf16 v[120:135], v[204:207], v[60:63], v[120:135]
    s_waitcnt vmcnt(6)
    v_mfma_f32_32x32x16_bf16 v[104:119], v[136:139], v[76:79], v[104:119]
    v_mfma_f32_32x32x16_bf16 v[120:135], v[140:143], v[76:79], v[120:135]
    s_waitcnt lgkmcnt(15)
    s_waitcnt vmcnt(5)
    v_mfma_f32_32x32x16_bf16 v[104:119], v[144:147], v[96:99], v[104:119]
    v_mfma_f32_32x32x16_bf16 v[120:135], v[148:151], v[96:99], v[120:135]
    s_waitcnt vmcnt(4)
    v_mfma_f32_32x32x16_bf16 v[104:119], v[152:155], v[100:103], v[104:119]
    v_mfma_f32_32x32x16_bf16 v[120:135], v[156:159], v[100:103], v[120:135]
    buffer_load_dwordx4 v[208:211], v9, s[24:27], s53 offen sc1
    buffer_load_dwordx4 v[212:215], v10, s[24:27], s53 offen sc1
    buffer_load_dwordx4 v[216:219], v220, s[24:27], s53 offen sc1
    s_waitcnt lgkmcnt(12)
    s_waitcnt vmcnt(6)
    v_mfma_f32_32x32x16_bf16 v[104:119], v[160:163], v[24:27], v[104:119]
    v_mfma_f32_32x32x16_bf16 v[120:135], v[164:167], v[24:27], v[120:135]
    s_mov_b32 s63, 32768
    s_nop 10
EW_85:
    ds_read_b128 v[18:21], v6 offset:80
    s_waitcnt lgkmcnt(0)
    v_min3_u32 v18, v18, v19, v20
    v_min_u32 v18, v18, v21
    s_nop 0
    v_readfirstlane_b32 s62, v18
    s_nop 0
    s_cmp_ge_u32 s62, 10
    s_cbranch_scc1 ED_86
    s_sub_u32 s63, s63, 1
    s_cmp_lg_u32 s63, 0
    s_cbranch_scc1 EW_85
ED_86:
    s_waitcnt vmcnt(5)
    v_mfma_f32_32x32x16_bf16 v[104:119], v[168:171], v[28:31], v[104:119]
    v_mfma_f32_32x32x16_bf16 v[120:135], v[172:175], v[28:31], v[120:135]
    s_waitcnt vmcnt(4)
    v_mfma_f32_32x32x16_bf16 v[104:119], v[176:179], v[32:35], v[104:119]
    v_mfma_f32_32x32x16_bf16 v[120:135], v[180:183], v[32:35], v[120:135]
    s_waitcnt vmcnt(3)
    v_mfma_f32_32x32x16_bf16 v[104:119], v[184:187], v[36:39], v[104:119]
    v_mfma_f32_32x32x16_bf16 v[120:135], v[188:191], v[36:39], v[120:135]
    s_bitcmp1_b32 s3, 0
    s_cbranch_scc1 G2_K1
    s_nop 9
    ds_write_b128 v11, v[120:123] offset:0
    ds_write_b128 v11, v[124:127] offset:1024
    ds_write_b128 v11, v[128:131] offset:2048
    ds_write_b128 v11, v[132:135] offset:3072
    v_mov_b32 v22, 11
    s_mov_b64 exec, 1
    ds_write_b32 v17, v22 offset:80
    s_mov_b64 exec, -1
    v_xor_b32 v19, 4, v17
    s_mov_b32 s63, 32768
    s_nop 1
PW_87:
    ds_read_b32 v18, v19 offset:80
    s_waitcnt lgkmcnt(0)
    v_cmp_gt_u32 vcc, 11, v18
    s_nop 1
    s_cbranch_vccz PD_88
    s_sub_u32 s63, s63, 1
    s_cmp_lg_u32 s63, 0
    s_cbranch_scc1 PW_87
PD_88:
    ds_read_b128 v[184:187], v12 offset:0
    ds_read_b128 v[188:191], v12 offset:1024
    ds_read_b128 v[192:195], v12 offset:2048
    ds_read_b128 v[196:199], v12 offset:3072
    s_waitcnt lgkmcnt(3)
    v_pk_add_f32 v[104:105], v[104:105], v[184:185]
    v_pk_add_f32 v[106:107], v[106:107], v[186:187]
    s_waitcnt lgkmcnt(2)
    v_pk_add_f32 v[108:109], v[108:109], v[188:189]
    v_pk_add_f32 v[110:111], v[110:111], v[190:191]
    v_cvt_pk_bf16_f32 v136, v104, v105
    v_cvt_pk_bf16_f32 v137, v106, v107
    v_cvt_pk_bf16_f32 v138, v108, v109
    v_cvt_pk_bf16_f32 v139, v110, v111
    s_nop 0
    v_permlane32_swap_b32 v136, v138
    v_permlane32_swap_b32 v137, v139
    s_waitcnt lgkmcnt(1)
    v_pk_add_f32 v[112:113], v[112:113], v[192:193]
    v_pk_add_f32 v[114:115], v[114:115], v[194:195]
    s_waitcnt lgkmcnt(0)
    v_pk_add_f32 v[116:117], v[116:117], v[196:197]
    v_pk_add_f32 v[118:119], v[118:119], v[198:199]
    v_cvt_pk_bf16_f32 v140, v112, v113
    v_cvt_pk_bf16_f32 v141, v114, v115
    v_cvt_pk_bf16_f32 v142, v116, v117
    v_cvt_pk_bf16_f32 v143, v118, v119
    s_nop 0
    v_permlane32_swap_b32 v140, v142
    v_permlane32_swap_b32 v141, v143
    v_lshlrev_b32 v152, 16, v136
    v_and_b32 v153, s39, v136
    v_lshlrev_b32 v154, 16, v137
    v_and_b32 v155, s39, v137
    v_lshlrev_b32 v156, 16, v138
    v_and_b32 v157, s39, v138
    v_lshlrev_b32 v158, 16, v139
    v_and_b32 v159, s39, v139
    v_lshlrev_b32 v160, 16, v140
    v_and_b32 v161, s39, v140
    v_lshlrev_b32 v162, 16, v141
    v_and_b32 v163, s39, v141
    v_lshlrev_b32 v164, 16, v142
    v_and_b32 v165, s39, v142
    v_lshlrev_b32 v166, 16, v143
    v_and_b32 v167, s39, v143
    s_waitcnt vmcnt(0)
    v_cmp_ne_u32 s[84:85], s52, v211
    v_cmp_ne_u32 s[86:87], s52, v215
    v_cmp_ne_u32 s[88:89], s52, v219
    s_or_b64 s[58:59], s[84:85], s[86:87]
    s_or_b64 s[58:59], s[58:59], s[88:89]
    s_cmp_eq_u64 s[58:59], 0
    s_cbranch_scc1 GD_90
    s_mov_b32 s63, 32768
GL_89:
    s_mov_b64 exec, s[84:85]
    buffer_load_dwordx4 v[208:211], v9, s[24:27], s53 offen sc1
    s_mov_b64 exec, s[86:87]
    buffer_load_dwordx4 v[212:215], v10, s[24:27], s53 offen sc1
    s_mov_b64 exec, s[88:89]
    buffer_load_dwordx4 v[216:219], v220, s[24:27], s53 offen sc1
    s_waitcnt vmcnt(0)
    s_mov_b64 exec, s[84:85]
    v_cmp_ne_u32 s[84:85], s52, v211
    s_mov_b64 exec, s[86:87]
    v_cmp_ne_u32 s[86:87], s52, v215
    s_mov_b64 exec, s[88:89]
    v_cmp_ne_u32 s[88:89], s52, v219
    s_mov_b64 exec, -1
    s_or_b64 s[58:59], s[84:85], s[86:87]
    s_or_b64 s[58:59], s[58:59], s[88:89]
    s_cmp_eq_u64 s[58:59], 0
    s_cbranch_scc1 GD_90
    s_sleep 2
    s_sub_u32 s63, s63, 1
    s_cmp_lg_u32 s63, 0
    s_cbranch_scc1 GL_89
GD_90:
    v_lshlrev_b32 v168, 16, v208
    v_and_b32 v169, s39, v208
    v_lshlrev_b32 v170, 16, v209
    v_and_b32 v171, s39, v209
    v_lshlrev_b32 v172, 16, v210
    v_and_b32 v173, s39, v210
    v_lshlrev_b32 v174, 16, v212
    v_and_b32 v175, s39, v212
    v_pk_add_f32 v[152:153], v[152:153], v[168:169]
    v_pk_add_f32 v[154:155], v[154:155], v[170:171]
    v_pk_add_f32 v[156:157], v[156:157], v[172:173]
    v_pk_add_f32 v[158:159], v[158:159], v[174:175]
    v_cvt_pk_bf16_f32 v136, v152, v153
    v_cvt_pk_bf16_f32 v137, v154, v155
    v_cvt_pk_bf16_f32 v138, v156, v157
    v_cvt_pk_bf16_f32 v139, v158, v159
    buffer_store_dwordx4 v[136:139], v7, s[28:31], s54 offen offset:0
    v_lshlrev_b32 v176, 16, v213
    v_and_b32 v177, s39, v213
    v_lshlrev_b32 v178, 16, v214
    v_and_b32 v179, s39, v214
    v_lshlrev_b32 v180, 16, v216
    v_and_b32 v181, s39, v216
    v_lshlrev_b32 v182, 16, v217
    v_and_b32 v183, s39, v217
    v_pk_add_f32 v[160:161], v[160:161], v[176:177]
    v_pk_add_f32 v[162:163], v[162:163], v[178:179]
    v_pk_add_f32 v[164:165], v[164:165], v[180:181]
    v_pk_add_f32 v[166:167], v[166:167], v[182:183]
    v_cvt_pk_bf16_f32 v140, v160, v161
    v_cvt_pk_bf16_f32 v141, v162, v163
    v_cvt_pk_bf16_f32 v142, v164, v165
    v_cvt_pk_bf16_f32 v143, v166, v167
    buffer_store_dwordx4 v[140:143], v7, s[28:31], s54 offen offset:32
    s_branch G2_KD
    s_nop 0
G2_K1:
    ds_write_b128 v11, v[104:107] offset:0
    ds_write_b128 v11, v[108:111] offset:1024
    ds_write_b128 v11, v[112:115] offset:2048
    ds_write_b128 v11, v[116:119] offset:3072
    v_mov_b32 v22, 11
    s_mov_b64 exec, 1
    ds_write_b32 v17, v22 offset:80
    s_mov_b64 exec, -1
    v_xor_b32 v19, 4, v17
    s_mov_b32 s63, 32768
    s_nop 1
PW_91:
    ds_read_b32 v18, v19 offset:80
    s_waitcnt lgkmcnt(0)
    v_cmp_gt_u32 vcc, 11, v18
    s_nop 1
    s_cbranch_vccz PD_92
    s_sub_u32 s63, s63, 1
    s_cmp_lg_u32 s63, 0
    s_cbranch_scc1 PW_91
PD_92:
    ds_read_b128 v[184:187], v12 offset:0
    ds_read_b128 v[188:191], v12 offset:1024
    ds_read_b128 v[192:195], v12 offset:2048
    ds_read_b128 v[196:199], v12 offset:3072
    s_waitcnt lgkmcnt(3)
    v_pk_add_f32 v[120:121], v[120:121], v[184:185]
    v_pk_add_f32 v[122:123], v[122:123], v[186:187]
    s_waitcnt lgkmcnt(2)
    v_pk_add_f32 v[124:125], v[124:125], v[188:189]
    v_pk_add_f32 v[126:127], v[126:127], v[190:191]
    v_cvt_pk_bf16_f32 v136, v120, v121
    v_cvt_pk_bf16_f32 v137, v122, v123
    v_cvt_pk_bf16_f32 v138, v124, v125
    v_cvt_pk_bf16_f32 v139, v126, v127
    s_nop 0
    v_permlane32_swap_b32 v136, v138
    v_permlane32_swap_b32 v137, v139
    s_waitcnt lgkmcnt(1)
    v_pk_add_f32 v[128:129], v[128:129], v[192:193]
    v_pk_add_f32 v[130:131], v[130:131], v[194:195]
    s_waitcnt lgkmcnt(0)
    v_pk_add_f32 v[132:133], v[132:133], v[196:197]
    v_pk_add_f32 v[134:135], v[134:135], v[198:199]
    v_cvt_pk_bf16_f32 v140, v128, v129
    v_cvt_pk_bf16_f32 v141, v130, v131
    v_cvt_pk_bf16_f32 v142, v132, v133
    v_cvt_pk_bf16_f32 v143, v134, v135
    s_nop 0
    v_permlane32_swap_b32 v140, v142
    v_permlane32_swap_b32 v141, v143
    v_lshlrev_b32 v152, 16, v136
    v_and_b32 v153, s39, v136
    v_lshlrev_b32 v154, 16, v137
    v_and_b32 v155, s39, v137
    v_lshlrev_b32 v156, 16, v138
    v_and_b32 v157, s39, v138
    v_lshlrev_b32 v158, 16, v139
    v_and_b32 v159, s39, v139
    v_lshlrev_b32 v160, 16, v140
    v_and_b32 v161, s39, v140
    v_lshlrev_b32 v162, 16, v141
    v_and_b32 v163, s39, v141
    v_lshlrev_b32 v164, 16, v142
    v_and_b32 v165, s39, v142
    v_lshlrev_b32 v166, 16, v143
    v_and_b32 v167, s39, v143
    s_waitcnt vmcnt(0)
    v_cmp_ne_u32 s[84:85], s52, v211
    v_cmp_ne_u32 s[86:87], s52, v215
    v_cmp_ne_u32 s[88:89], s52, v219
    s_or_b64 s[58:59], s[84:85], s[86:87]
    s_or_b64 s[58:59], s[58:59], s[88:89]
    s_cmp_eq_u64 s[58:59], 0
    s_cbranch_scc1 GD_94
    s_mov_b32 s63, 32768
GL_93:
    s_mov_b64 exec, s[84:85]
    buffer_load_dwordx4 v[208:211], v9, s[24:27], s53 offen sc1
    s_mov_b64 exec, s[86:87]
    buffer_load_dwordx4 v[212:215], v10, s[24:27], s53 offen sc1
    s_mov_b64 exec, s[88:89]
    buffer_load_dwordx4 v[216:219], v220, s[24:27], s53 offen sc1
    s_waitcnt vmcnt(0)
    s_mov_b64 exec, s[84:85]
    v_cmp_ne_u32 s[84:85], s52, v211
    s_mov_b64 exec, s[86:87]
    v_cmp_ne_u32 s[86:87], s52, v215
    s_mov_b64 exec, s[88:89]
    v_cmp_ne_u32 s[88:89], s52, v219
    s_mov_b64 exec, -1
    s_or_b64 s[58:59], s[84:85], s[86:87]
    s_or_b64 s[58:59], s[58:59], s[88:89]
    s_cmp_eq_u64 s[58:59], 0
    s_cbranch_scc1 GD_94
    s_sleep 2
    s_sub_u32 s63, s63, 1
    s_cmp_lg_u32 s63, 0
    s_cbranch_scc1 GL_93
GD_94:
    v_lshlrev_b32 v168, 16, v208
    v_and_b32 v169, s39, v208
    v_lshlrev_b32 v170, 16, v209
    v_and_b32 v171, s39, v209
    v_lshlrev_b32 v172, 16, v210
    v_and_b32 v173, s39, v210
    v_lshlrev_b32 v174, 16, v212
    v_and_b32 v175, s39, v212
    v_pk_add_f32 v[152:153], v[152:153], v[168:169]
    v_pk_add_f32 v[154:155], v[154:155], v[170:171]
    v_pk_add_f32 v[156:157], v[156:157], v[172:173]
    v_pk_add_f32 v[158:159], v[158:159], v[174:175]
    v_cvt_pk_bf16_f32 v136, v152, v153
    v_cvt_pk_bf16_f32 v137, v154, v155
    v_cvt_pk_bf16_f32 v138, v156, v157
    v_cvt_pk_bf16_f32 v139, v158, v159
    buffer_store_dwordx4 v[136:139], v7, s[28:31], s54 offen offset:0
    v_lshlrev_b32 v176, 16, v213
    v_and_b32 v177, s39, v213
    v_lshlrev_b32 v178, 16, v214
    v_and_b32 v179, s39, v214
    v_lshlrev_b32 v180, 16, v216
    v_and_b32 v181, s39, v216
    v_lshlrev_b32 v182, 16, v217
    v_and_b32 v183, s39, v217
    v_pk_add_f32 v[160:161], v[160:161], v[176:177]
    v_pk_add_f32 v[162:163], v[162:163], v[178:179]
    v_pk_add_f32 v[164:165], v[164:165], v[180:181]
    v_pk_add_f32 v[166:167], v[166:167], v[182:183]
    v_cvt_pk_bf16_f32 v140, v160, v161
    v_cvt_pk_bf16_f32 v141, v162, v163
    v_cvt_pk_bf16_f32 v142, v164, v165
    v_cvt_pk_bf16_f32 v143, v166, v167
    buffer_store_dwordx4 v[140:143], v7, s[28:31], s54 offen offset:32
    s_nop 1
G2_KD:
G_EXIT:
K_END:
    s_endpgm
.p2align 8
K_TAB:
.long 0x3c003c00,0x3c003c00,0x3c003c00,0x3c003c00,0x3bd93c00,0x3aa73b64,0x387239a8,0x323e361f
.long 0x3b643c00,0x361f39a8,0xb61f0000,0xbb64b9a8,0x3aa73c00,0xb23e361f,0xbbd9b9a8,0xb872bb64
.long 0x39a83c00,0xb9a80000,0xb9a8bc00,0x39a80000,0x38723c00,0xbbd9b61f,0x323eb9a8,0x3aa73b64
.long 0x361f3c00,0xbb64b9a8,0x3b640000,0xb61f39a8,0x323e3c00,0xb872bb64,0x3aa739a8,0xbbd9b61f
.long 0x3c00,0xbc00,0x3c00,0xbc00,0xb23e3c00,0x3872bb64,0xbaa739a8,0x3bd9b61f
.long 0xb61f3c00,0x3b64b9a8,0xbb640000,0x361f39a8,0xb8723c00,0x3bd9b61f,0xb23eb9a8,0xbaa73b64
.long 0xb9a83c00,0x39a80000,0x39a8bc00,0xb9a80000,0xbaa73c00,0x323e361f,0x3bd9b9a8,0x3872bb64
.long 0xbb643c00,0xb61f39a8,0x361f0000,0x3b64b9a8,0xbbd93c00,0xbaa73b64,0xb87239a8,0xb23e361f
.long 0x3c003c00,0x3c003c00,0x3c003c00,0x3c003c00,0xb23e0000,0xb872b61f,0xbaa7b9a8,0xbbd9bb64
.long 0xbb64bc00,0xb61fb9a8,0x361f0000,0x3b6439a8,0x38720000,0x3bd93b64,0x323e39a8,0xbaa7b61f
.long 0x39a83c00,0xb9a80000,0xb9a8bc00,0x39a80000,0xbaa70000,0xb23ebb64,0x3bd939a8,0xb872361f
.long 0xb61fbc00,0x3b6439a8,0xbb640000,0x361fb9a8,0x3bd90000,0xbaa7361f,0x3872b9a8,0xb23e3b64
.long 0x3c00,0xbc00,0x3c00,0xbc00,0xbbd90000,0x3aa7361f,0xb872b9a8,0x323e3b64
.long 0x361fbc00,0xbb6439a8,0x3b640000,0xb61fb9a8,0x3aa70000,0x323ebb64,0xbbd939a8,0x3872361f
.long 0xb9a83c00,0x39a80000,0x39a8bc00,0xb9a80000,0xb8720000,0xbbd93b64,0xb23e39a8,0x3aa7b61f
.long 0x3b64bc00,0x361fb9a8,0xb61f0000,0xbb6439a8,0x323e0000,0x3872b61f,0x3aa7b9a8,0x3bd9bb64
.long 0x3c003c00,0x3c003c00,0x3c003c00,0x3c003c00,0xbbd9bc00,0xbaa7bb64,0xb872b9a8,0xb23eb61f
.long 0x3b643c00,0x361f39a8,0xb61f0000,0xbb64b9a8,0xbaa7bc00,0x323eb61f,0x3bd939a8,0x38723b64
.long 0x39a83c00,0xb9a80000,0xb9a8bc00,0x39a80000,0xb872bc00,0x3bd9361f,0xb23e39a8,0xbaa7bb64
.long 0x361f3c00,0xbb64b9a8,0x3b640000,0xb61f39a8,0xb23ebc00,0x38723b64,0xbaa7b9a8,0x3bd9361f
.long 0x3c00,0xbc00,0x3c00,0xbc00,0x323ebc00,0xb8723b64,0x3aa7b9a8,0xbbd9361f
.long 0xb61f3c00,0x3b64b9a8,0xbb640000,0x361f39a8,0x3872bc00,0xbbd9361f,0x323e39a8,0x3aa7bb64
.long 0xb9a83c00,0x39a80000,0x39a8bc00,0xb9a80000,0x3aa7bc00,0xb23eb61f,0xbbd939a8,0xb8723b64
.long 0xbb643c00,0xb61f39a8,0x361f0000,0x3b64b9a8,0x3bd9bc00,0x3aa7bb64,0x3872b9a8,0x323eb61f
.long 0x3c003c00,0x3c003c00,0x3c003c00,0x3c003c00,0x323e0000,0x3872361f,0x3aa739a8,0x3bd93b64
.long 0xbb64bc00,0xb61fb9a8,0x361f0000,0x3b6439a8,0xb8720000,0xbbd9bb64,0xb23eb9a8,0x3aa7361f
.long 0x39a83c00,0xb9a80000,0xb9a8bc00,0x39a80000,0x3aa70000,0x323e3b64,0xbbd9b9a8,0x3872b61f
.long 0xb61fbc00,0x3b6439a8,0xbb640000,0x361fb9a8,0xbbd90000,0x3aa7b61f,0xb87239a8,0x323ebb64
.long 0x3c00,0xbc00,0x3c00,0xbc00,0x3bd90000,0xbaa7b61f,0x387239a8,0xb23ebb64
.long 0x361fbc00,0xbb6439a8,0x3b640000,0xb61fb9a8,0xbaa70000,0xb23e3b64,0x3bd9b9a8,0xb872b61f
.long 0xb9a83c00,0x39a80000,0x39a8bc00,0xb9a80000,0x38720000,0x3bd9bb64,0x323eb9a8,0xbaa7361f
.long 0x3b64bc00,0x361fb9a8,0xb61f0000,0xbb6439a8,0xb23e0000,0xb872361f,0xbaa739a8,0xbbd93b64
.long 0xbc003c00,0xbc003c00,0xbc003c00,0xbc003c00,0xb23e8000,0xb872b61f,0xbaa7b9a8,0xbbd9bb64
.long 0xb61f8000,0xbb64b9a8,0xbb64bc00,0xb61fb9a8,0xb8728000,0xbbd9bb64,0xb23eb9a8,0x3aa7361f
.long 0xb9a88000,0xb9a8bc00,0x39a88000,0x39a83c00,0xbaa78000,0xb23ebb64,0x3bd939a8,0xb872361f
.long 0xbb648000,0x361fb9a8,0x361f3c00,0xbb64b9a8,0xbbd98000,0x3aa7b61f,0xb87239a8,0x323ebb64
.long 0xbc008000,0x3c008000,0xbc008000,0x3c008000,0xbbd98000,0x3aa7361f,0xb872b9a8,0x323e3b64
.long 0xbb648000,0x361f39a8,0x361fbc00,0xbb6439a8,0xbaa78000,0xb23e3b64,0x3bd9b9a8,0xb872b61f
.long 0xb9a88000,0xb9a83c00,0x39a88000,0x39a8bc00,0xb8728000,0xbbd93b64,0xb23e39a8,0x3aa7b61f
.long 0xb61f8000,0xbb6439a8,0xbb643c00,0xb61f39a8,0xb23e8000,0xb872361f,0xbaa739a8,0xbbd93b64
.long 0xbc003c00,0xbc003c00,0xbc003c00,0xbc003c00,0xbbd9bc00,0xbaa7bb64,0xb872b9a8,0xb23eb61f
.long 0x361f8000,0x3b6439a8,0x3b643c00,0x361f39a8,0x3aa73c00,0xb23e361f,0xbbd9b9a8,0xb872bb64
.long 0xb9a88000,0xb9a8bc00,0x39a88000,0x39a83c00,0xb872bc00,0x3bd9361f,0xb23e39a8,0xbaa7bb64
.long 0x3b648000,0xb61f39a8,0xb61fbc00,0x3b6439a8,0x323e3c00,0xb872bb64,0x3aa739a8,0xbbd9b61f
.long 0xbc008000,0x3c008000,0xbc008000,0x3c008000,0x323ebc00,0xb8723b64,0x3aa7b9a8,0xbbd9361f
.long 0x3b648000,0xb61fb9a8,0xb61f3c00,0x3b64b9a8,0xb8723c00,0x3bd9b61f,0xb23eb9a8,0xbaa73b64
.long 0xb9a88000,0xb9a83c00,0x39a88000,0x39a8bc00,0x3aa7bc00,0xb23eb61f,0xbbd939a8,0xb8723b64
.long 0x361f8000,0x3b64b9a8,0x3b64bc00,0x361fb9a8,0xbbd93c00,0xbaa73b64,0xb87239a8,0xb23e361f
.long 0xbc003c00,0xbc003c00,0xbc003c00,0xbc003c00,0x323e8000,0x3872361f,0x3aa739a8,0x3bd93b64
.long 0xb61f8000,0xbb64b9a8,0xbb64bc00,0xb61fb9a8,0x38728000,0x3bd93b64,0x323e39a8,0xbaa7b61f
.long 0xb9a88000,0xb9a8bc00,0x39a88000,0x39a83c00,0x3aa78000,0x323e3b64,0xbbd9b9a8,0x3872b61f
.long 0xbb648000,0x361fb9a8,0x361f3c00,0xbb64b9a8,0x3bd98000,0xbaa7361f,0x3872b9a8,0xb23e3b64
.long 0xbc008000,0x3c008000,0xbc008000,0x3c008000,0x3bd98000,0xbaa7b61f,0x387239a8,0xb23ebb64
.long 0xbb648000,0x361f39a8,0x361fbc00,0xbb6439a8,0x3aa78000,0x323ebb64,0xbbd939a8,0x3872361f
.long 0xb9a88000,0xb9a83c00,0x39a88000,0x39a8bc00,0x38728000,0x3bd9bb64,0x323eb9a8,0xbaa7361f
.long 0xb61f8000,0xbb6439a8,0xbb643c00,0xb61f39a8,0x323e8000,0x3872b61f,0x3aa7b9a8,0x3bd9bb64
.long 0xbc003c00,0xbc003c00,0xbc003c00,0xbc003c00,0x3bd93c00,0x3aa73b64,0x387239a8,0x323e361f
.long 0x361f8000,0x3b6439a8,0x3b643c00,0x361f39a8,0xbaa7bc00,0x323eb61f,0x3bd939a8,0x38723b64
.long 0xb9a88000,0xb9a8bc00,0x39a88000,0x39a83c00,0x38723c00,0xbbd9b61f,0x323eb9a8,0x3aa73b64
.long 0x3b648000,0xb61f39a8,0xb61fbc00,0x3b6439a8,0xb23ebc00,0x38723b64,0xbaa7b9a8,0x3bd9361f
.long 0xbc008000,0x3c008000,0xbc008000,0x3c008000,0xb23e3c00,0x3872bb64,0xbaa739a8,0x3bd9b61f
.long 0x3b648000,0xb61fb9a8,0xb61f3c00,0x3b64b9a8,0x3872bc00,0xbbd9361f,0x323e39a8,0x3aa7bb64
.long 0xb9a88000,0xb9a83c00,0x39a88000,0x39a8bc00,0xbaa73c00,0x323e361f,0x3bd9b9a8,0x3872bb64
.long 0x361f8000,0x3b64b9a8,0x3b64bc00,0x361fb9a8,0x3bd9bc00,0x3aa7bb64,0x3872b9a8,0x323eb61f
.long 0x3f800000,0x3f800000,0x3f800000,0x3f800000,0x3f800000,0x3f7ffb11,0x3f7fec43,0x3f7fd397
.long 0x3f800000,0x3f7fec43,0x3f7fb10f,0x3f7f4e6d,0x3f800000,0x3f7fd397,0x3f7f4e6d,0x3f7e70b0
.long 0x3f800000,0x3f7fb10f,0x3f7ec46d,0x3f7d3aac,0x3f800000,0x3f7f84ab,0x3f7e1324,0x3f7baccd
.long 0x3f800000,0x3f7f4e6d,0x3f7d3aac,0x3f79c79d,0x3f800000,0x3f7f0e58,0x3f7c3b28,0x3f778bc5
.long 0x3f800000,0x3f7ec46d,0x3f7b14be,0x3f74fa0b,0x3f800000,0x3f7e70b0,0x3f79c79d,0x3f721352
.long 0x3f800000,0x3f7e1324,0x3f7853f8,0x3f6ed89e,0x3f800000,0x3f7dabcc,0x3f76ba07,0x3f6b4b0c
.long 0x3f800000,0x3f7d3aac,0x3f74fa0b,0x3f676bd8,0x3f800000,0x3f7cbfc9,0x3f731447,0x3f633c5a
.long 0x3f800000,0x3f7c3b28,0x3f710908,0x3f5ebe05,0x3f800000,0x3f7baccd,0x3f6ed89e,0x3f59f26a
.long 0x3f800000,0x3f800000,0x3f800000,0x3f800000,0x3f7fb10f,0x3f7f84ab,0x3f7f4e6d,0x3f7f0e58
.long 0x3f7ec46d,0x3f7e1324,0x3f7d3aac,0x3f7c3b28,0x3f7d3aac,0x3f7baccd,0x3f79c79d,0x3f778bc5
.long 0x3f7b14be,0x3f7853f8,0x3f74fa0b,0x3f710908,0x3f7853f8,0x3f740bdd,0x3f6ed89e,0x3f68bf3c
.long 0x3f74fa0b,0x3f6ed89e,0x3f676bd8,0x3f5ebe05,0x3f710908,0x3f68bf3c,0x3f5ebe05,0x3f531849
.long 0x3f6c835e,0x3f61c598,0x3f54db31,0x3f45e403,0x3f676bd8,0x3f59f26a,0x3f49d112,0x3f373a23
.long 0x3f61c598,0x3f514d3d,0x3f3daef9,0x3f273656,0x3f5b941a,0x3f47de65,0x3f3085bb,0x3f15f6d9
.long 0x3f54db31,0x3f3daef9,0x3f226799,0x3f039c3d,0x3f4d9f02,0x3f32c8c9,0x3f13682a,0x3ee0924f
.long 0x3f45e403,0x3f273656,0x3f039c3d,0x3eb8442a,0x3f3daef9,0x3f1b02c6,0x3ee63375,0x3e8e9a22
.long 0x3f800000,0x3f800000,0x3f800000,0x3f800000,0x3f7ec46d,0x3f7e70b0,0x3f7e1324,0x3f7dabcc
.long 0x3f7b14be,0x3f79c79d,0x3f7853f8,0x3f76ba07,0x3f74fa0b,0x3f721352,0x3f6ed89e,0x3f6b4b0c
.long 0x3f6c835e,0x3f676bd8,0x3f61c598,0x3f5b941a,0x3f61c598,0x3f59f26a,0x3f514d3d,0x3f47de65
.long 0x3f54db31,0x3f49d112,0x3f3daef9,0x3f3085bb,0x3f45e403,0x3f373a23,0x3f273656,0x3f15f6d9
.long 0x3f3504f3,0x3f226799,0x3f0e39da,0x3ef15aea,0x3f226799,0x3f0b9a6b,0x3ee63375,0x3eb263ef
.long 0x3f0e39da,0x3ee63375,0x3eac7cd4,0x3e605c13,0x3ef15aea,0x3eb263ef,0x3e605c13,0x3dafb680
.long 0x3ec3ef15,0x3e78cfcc,0x3dc8bd36,0xbd48fb30,0x3e94a031,0x3e09cf86,0xbcc90ab0,0xbe3b6ecf
.long 0x3e47c5c2,0x3cc90ab0,0xbe164083,0xbea09ae5,0x3dc8bd36,0xbdafb680,0xbe888e93,0xbee0924f
.long 0x3f800000,0x3f800000,0x3f800000,0x3f800000,0x3f7d3aac,0x3f7cbfc9,0x3f7c3b28,0x3f7baccd
.long 0x3f74fa0b,0x3f731447,0x3f710908,0x3f6ed89e,0x3f676bd8,0x3f633c5a,0x3f5ebe05,0x3f59f26a
.long 0x3f54db31,0x3f4d9f02,0x3f45e403,0x3f3daef9,0x3f3daef9,0x3f32c8c9,0x3f273656,0x3f1b02c6
.long 0x3f226799,0x3f13682a,0x3f039c3d,0x3ee63375,0x3f039c3d,0x3ee0924f,0x3eb8442a,0x3e8e9a22
.long 0x3ec3ef15,0x3e94a031,0x3e47c5c2,0x3dc8bd36,0x3e78cfcc,0x3e09cf86,0x3cc90ab0,0xbdafb680
.long 0x3dc8bd36,0xbcc90ab0,0xbe164083,0xbe888e93,0xbd48fb30,0xbe3b6ecf,0xbea09ae5,0xbee0924f
.long 0xbe47c5c2,0xbeac7cd4,0xbef15aea,0xbf187fc0,0xbeac7cd4,0xbef6e0cb,0xbf1d7fd1,0xbf3b8f3b
.long 0xbef15aea,0xbf1d7fd1,0xbf3daef9,0xbf584853,0xbf187fc0,0xbf3b8f3b,0xbf584853,0xbf6db293
.long 0x0,0x0,0x0,0x0,0x0,0x3c490e90,0x3cc90ab0,0x3d16c32c
.long 0x0,0x3cc90ab0,0x3d48fb30,0x3d96a905,0x0,0x3d16c32c,0x3d96a905,0x3de1bc2e
.long 0x0,0x3d48fb30,0x3dc8bd36,0x3e164083,0x0,0x3d7b2b74,0x3dfab273,0x3e3b6ecf
.long 0x0,0x3d96a905,0x3e164083,0x3e605c13,0x0,0x3dafb680,0x3e2f10a2,0x3e827dc0
.long 0x0,0x3dc8bd36,0x3e47c5c2,0x3e94a031,0x0,0x3de1bc2e,0x3e605c13,0x3ea68f12
.long 0x0,0x3dfab273,0x3e78cfcc,0x3eb8442a,0x0,0x3e09cf86,0x3e888e93,0x3ec9b953
.long 0x0,0x3e164083,0x3e94a031,0x3edae880,0x0,0x3e22abb6,0x3ea09ae5,0x3eebcbbb
.long 0x0,0x3e2f10a2,0x3eac7cd4,0x3efc5d27,0x0,0x3e3b6ecf,0x3eb8442a,0x3f064b82
.long 0x0,0x0,0x0,0x0,0x3d48fb30,0x3d7b2b74,0x3d96a905,0x3dafb680
.long 0x3dc8bd36,0x3dfab273,0x3e164083,0x3e2f10a2,0x3e164083,0x3e3b6ecf,0x3e605c13,0x3e827dc0
.long 0x3e47c5c2,0x3e78cfcc,0x3e94a031,0x3eac7cd4,0x3e78cfcc,0x3e9aa086,0x3eb8442a,0x3ed53641
.long 0x3e94a031,0x3eb8442a,0x3edae880,0x3efc5d27,0x3eac7cd4,0x3ed53641,0x3efc5d27,0x3f10d3cd
.long 0x3ec3ef15,0x3ef15aea,0x3f0e39da,0x3f226799,0x3edae880,0x3f064b82,0x3f1d7fd1,0x3f32c8c9
.long 0x3ef15aea,0x3f13682a,0x3f2beb4a,0x3f41d870,0x3f039c3d,0x3f1ff6cb,0x3f396842,0x3f4f7a1f
.long 0x3f0e39da,0x3f2beb4a,0x3f45e403,0x3f5b941a,0x3f187fc0,0x3f373a23,0x3f514d3d,0x3f660f88
.long 0x3f226799,0x3f41d870,0x3f5b941a,0x3f6ed89e,0x3f2beb4a,0x3f4bbbf8,0x3f64aa59,0x3f75dec6
.long 0x0,0x0,0x0,0x0,0x3dc8bd36,0x3de1bc2e,0x3dfab273,0x3e09cf86
.long 0x3e47c5c2,0x3e605c13,0x3e78cfcc,0x3e888e93,0x3e94a031,0x3ea68f12,0x3eb8442a,0x3ec9b953
.long 0x3ec3ef15,0x3edae880,0x3ef15aea,0x3f039c3d,0x3ef15aea,0x3f064b82,0x3f13682a,0x3f1ff6cb
.long 0x3f0e39da,0x3f1d7fd1,0x3f2beb4a,0x3f396842,0x3f226799,0x3f32c8c9,0x3f41d870,0x3f4f7a1f
.long 0x3f3504f3,0x3f45e403,0x3f54db31,0x3f61c598,0x3f45e403,0x3f5695e5,0x3f64aa59,0x3f6ff573
.long 0x3f54db31,0x3f64aa59,0x3f710908,0x3f79c79d,0x3f61c598,0x3f6ff573,0x3f79c79d,0x3f7f0e58
.long 0x3f6c835e,0x3f7853f8,0x3f7ec46d,0x3f7fb10f,0x3f74fa0b,0x3f7dabcc,0x3f7fec43,0x3f7baccd
.long 0x3f7b14be,0x3f7fec43,0x3f7d3aac,0x3f731447,0x3f7ec46d,0x3f7f0e58,0x3f76ba07,0x3f660f88
.long 0x0,0x0,0x0,0x0,0x3e164083,0x3e22abb6,0x3e2f10a2,0x3e3b6ecf
.long 0x3e94a031,0x3ea09ae5,0x3eac7cd4,0x3eb8442a,0x3edae880,0x3eebcbbb,0x3efc5d27,0x3f064b82
.long 0x3f0e39da,0x3f187fc0,0x3f226799,0x3f2beb4a,0x3f2beb4a,0x3f373a23,0x3f41d870,0x3f4bbbf8
.long 0x3f45e403,0x3f514d3d,0x3f5b941a,0x3f64aa59,0x3f5b941a,0x3f660f88,0x3f6ed89e,0x3f75dec6
.long 0x3f6c835e,0x3f74fa0b,0x3f7b14be,0x3f7ec46d,0x3f7853f8,0x3f7dabcc,0x3f7fec43,0x3f7f0e58
.long 0x3f7ec46d,0x3f7fec43,0x3f7d3aac,0x3f76ba07,0x3f7fb10f,0x3f7baccd,0x3f731447,0x3f660f88
.long 0x3f7b14be,0x3f710908,0x3f61c598,0x3f4d9f02,0x3f710908,0x3f604621,0x3f49d112,0x3f2e3bde
.long 0x3f61c598,0x3f49d112,0x3f2beb4a,0x3f08f59b,0x3f4d9f02,0x3f2e3bde,0x3f08f59b,0x3ebe1d4a
.long 0x3c003c00,0x3c003c00,0x0,0x0,0x3b643c00,0x361f39a8,0x361f0000,0x3b6439a8
.long 0x39a83c00,0xb9a80000,0x39a80000,0x39a83c00,0x361f3c00,0xbb64b9a8,0x3b640000,0xb61f39a8
.long 0x3c00,0xbc00,0x3c000000,0xbc000000,0xb61f3c00,0x3b64b9a8,0x3b640000,0xb61fb9a8
.long 0xb9a83c00,0x39a80000,0x39a80000,0x39a8bc00,0xbb643c00,0xb61f39a8,0x361f0000,0x3b64b9a8
.long 0xbc003c00,0xbc003c00,0x0,0x0,0xbb643c00,0xb61f39a8,0xb61f0000,0xbb6439a8
.long 0xb9a83c00,0x39a80000,0xb9a80000,0xb9a83c00,0xb61f3c00,0x3b64b9a8,0xbb640000,0x361f39a8
.long 0x3c00,0xbc00,0xbc000000,0x3c000000,0x361f3c00,0xbb64b9a8,0xbb640000,0x361fb9a8
.long 0x39a83c00,0xb9a80000,0xb9a80000,0xb9a8bc00,0x3b643c00,0x361f39a8,0xb61f0000,0xbb64b9a8
.long 0x3c003c00,0x3c003c00,0x0,0x0,0xb61f0000,0xbb64b9a8,0x3b643c00,0x361f39a8
.long 0xb9a8bc00,0x39a80000,0xb9a80000,0xb9a8bc00,0x3b640000,0xb61f39a8,0xb61fbc00,0x3b6439a8
.long 0x3c00,0xbc00,0x3c000000,0xbc000000,0xbb640000,0x361f39a8,0xb61f3c00,0x3b64b9a8
.long 0x39a8bc00,0xb9a80000,0xb9a80000,0xb9a83c00,0x361f0000,0x3b64b9a8,0x3b64bc00,0x361fb9a8
.long 0xbc003c00,0xbc003c00,0x0,0x0,0x361f0000,0x3b64b9a8,0xbb643c00,0xb61f39a8
.long 0x39a8bc00,0xb9a80000,0x39a80000,0x39a8bc00,0xbb640000,0x361f39a8,0x361fbc00,0xbb6439a8
.long 0x3c00,0xbc00,0xbc000000,0x3c000000,0x3b640000,0xb61f39a8,0x361f3c00,0xbb64b9a8
.long 0xb9a8bc00,0x39a80000,0x39a80000,0x39a83c00,0xb61f0000,0xbb64b9a8,0xbb64bc00,0xb61fb9a8
.long 0x3c003c00,0x3c003c00,0x0,0x0,0xbb64bc00,0xb61fb9a8,0xb61f0000,0xbb64b9a8
.long 0x39a83c00,0xb9a80000,0x39a80000,0x39a83c00,0xb61fbc00,0x3b6439a8,0xbb640000,0x361fb9a8
.long 0x3c00,0xbc00,0x3c000000,0xbc000000,0x361fbc00,0xbb6439a8,0xbb640000,0x361f39a8
.long 0xb9a83c00,0x39a80000,0x39a80000,0x39a8bc00,0x3b64bc00,0x361fb9a8,0xb61f0000,0xbb6439a8
.long 0xbc003c00,0xbc003c00,0x0,0x0,0x3b64bc00,0x361fb9a8,0x361f0000,0x3b64b9a8
.long 0xb9a83c00,0x39a80000,0xb9a80000,0xb9a83c00,0x361fbc00,0xbb6439a8,0x3b640000,0xb61fb9a8
.long 0x3c00,0xbc00,0xbc000000,0x3c000000,0xb61fbc00,0x3b6439a8,0x3b640000,0xb61f39a8
.long 0x39a83c00,0xb9a80000,0xb9a80000,0xb9a8bc00,0xbb64bc00,0xb61fb9a8,0x361f0000,0x3b6439a8
.long 0x3c003c00,0x3c003c00,0x0,0x0,0x361f0000,0x3b6439a8,0xbb64bc00,0xb61fb9a8
.long 0xb9a8bc00,0x39a80000,0xb9a80000,0xb9a8bc00,0xbb640000,0x361fb9a8,0x361f3c00,0xbb64b9a8
.long 0x3c00,0xbc00,0x3c000000,0xbc000000,0x3b640000,0xb61fb9a8,0x361fbc00,0xbb6439a8
.long 0x39a8bc00,0xb9a80000,0xb9a80000,0xb9a83c00,0xb61f0000,0xbb6439a8,0xbb643c00,0xb61f39a8
.long 0xbc003c00,0xbc003c00,0x0,0x0,0xb61f0000,0xbb6439a8,0x3b64bc00,0x361fb9a8
.long 0x39a8bc00,0xb9a80000,0x39a80000,0x39a8bc00,0x3b640000,0xb61fb9a8,0xb61f3c00,0x3b64b9a8
.long 0x3c00,0xbc00,0xbc000000,0x3c000000,0xbb640000,0x361fb9a8,0xb61fbc00,0x3b6439a8
.long 0xb9a8bc00,0x39a80000,0x39a80000,0x39a83c00,0x361f0000,0x3b6439a8,0x3b643c00,0x361f39a8
.long 0x80008000,0x80008000,0x3c003c00,0x3c003c00,0xb61f8000,0xbb64b9a8,0x3b643c00,0x361f39a8
.long 0xb9a88000,0xb9a8bc00,0x39a83c00,0xb9a80000,0xbb648000,0x361fb9a8,0x361f3c00,0xbb64b9a8
.long 0xbc008000,0x3c008000,0x3c00,0xbc00,0xbb648000,0x361f39a8,0xb61f3c00,0x3b64b9a8
.long 0xb9a88000,0xb9a83c00,0xb9a83c00,0x39a80000,0xb61f8000,0xbb6439a8,0xbb643c00,0xb61f39a8
.long 0x0,0x0,0x3c00bc00,0x3c00bc00,0xb61f0000,0xbb6439a8,0x3b64bc00,0x361fb9a8
.long 0xb9a80000,0xb9a83c00,0x39a8bc00,0xb9a88000,0xbb640000,0x361f39a8,0x361fbc00,0xbb6439a8
.long 0xbc000000,0x3c000000,0x8000bc00,0x80003c00,0xbb640000,0x361fb9a8,0xb61fbc00,0x3b6439a8
.long 0xb9a80000,0xb9a8bc00,0xb9a8bc00,0x39a88000,0xb61f0000,0xbb64b9a8,0xbb64bc00,0xb61fb9a8
.long 0x80008000,0x80008000,0x3c003c00,0x3c003c00,0xbb64bc00,0xb61fb9a8,0xb61f0000,0xbb64b9a8
.long 0x39a88000,0x39a83c00,0xb9a8bc00,0x39a80000,0x361f3c00,0xbb64b9a8,0x3b640000,0xb61f39a8
.long 0xbc008000,0x3c008000,0x3c00,0xbc00,0x361fbc00,0xbb6439a8,0xbb640000,0x361f39a8
.long 0x39a88000,0x39a8bc00,0x39a8bc00,0xb9a80000,0xbb643c00,0xb61f39a8,0x361f0000,0x3b64b9a8
.long 0x0,0x0,0x3c00bc00,0x3c00bc00,0xbb643c00,0xb61f39a8,0xb61f8000,0xbb6439a8
.long 0x39a80000,0x39a8bc00,0xb9a83c00,0x39a88000,0x361fbc00,0xbb6439a8,0x3b648000,0xb61fb9a8
.long 0xbc000000,0x3c000000,0x8000bc00,0x80003c00,0x361f3c00,0xbb64b9a8,0xbb648000,0x361fb9a8
.long 0x39a80000,0x39a83c00,0x39a83c00,0xb9a88000,0xbb64bc00,0xb61fb9a8,0x361f8000,0x3b6439a8
.long 0x80008000,0x80008000,0x3c003c00,0x3c003c00,0x361f8000,0x3b6439a8,0xbb64bc00,0xb61fb9a8
.long 0xb9a88000,0xb9a8bc00,0x39a83c00,0xb9a80000,0x3b648000,0xb61f39a8,0xb61fbc00,0x3b6439a8
.long 0xbc008000,0x3c008000,0x3c00,0xbc00,0x3b648000,0xb61fb9a8,0x361fbc00,0xbb6439a8
.long 0xb9a88000,0xb9a83c00,0xb9a83c00,0x39a80000,0x361f8000,0x3b64b9a8,0x3b64bc00,0x361fb9a8
.long 0x0,0x0,0x3c00bc00,0x3c00bc00,0x361f0000,0x3b64b9a8,0xbb643c00,0xb61f39a8
.long 0xb9a80000,0xb9a83c00,0x39a8bc00,0xb9a88000,0x3b640000,0xb61fb9a8,0xb61f3c00,0x3b64b9a8
.long 0xbc000000,0x3c000000,0x8000bc00,0x80003c00,0x3b640000,0xb61f39a8,0x361f3c00,0xbb64b9a8
.long 0xb9a80000,0xb9a8bc00,0xb9a8bc00,0x39a88000,0x361f0000,0x3b6439a8,0x3b643c00,0x361f39a8
.long 0x80008000,0x80008000,0x3c003c00,0x3c003c00,0x3b643c00,0x361f39a8,0x361f0000,0x3b6439a8
.long 0x39a88000,0x39a83c00,0xb9a8bc00,0x39a80000,0xb61fbc00,0x3b6439a8,0xbb640000,0x361fb9a8
.long 0xbc008000,0x3c008000,0x3c00,0xbc00,0xb61f3c00,0x3b64b9a8,0x3b640000,0xb61fb9a8
.long 0x39a88000,0x39a8bc00,0x39a8bc00,0xb9a80000,0x3b64bc00,0x361fb9a8,0xb61f0000,0xbb6439a8
.long 0x0,0x0,0x3c00bc00,0x3c00bc00,0x3b64bc00,0x361fb9a8,0x361f8000,0x3b64b9a8
.long 0x39a80000,0x39a8bc00,0xb9a83c00,0x39a88000,0xb61f3c00,0x3b64b9a8,0xbb648000,0x361f39a8
.long 0xbc000000,0x3c000000,0x8000bc00,0x80003c00,0xb61fbc00,0x3b6439a8,0x3b648000,0xb61f39a8
.long 0x39a80000,0x39a83c00,0x39a83c00,0xb9a88000,0x3b643c00,0x361f39a8,0xb61f8000,0xbb64b9a8
.long 0x3c003c00,0x3c003c00,0x0,0x0,0x3b643c00,0x361f39a8,0x0,0x0
.long 0x39a83c00,0xb9a80000,0x0,0x0,0x361f3c00,0xbb64b9a8,0x0,0x0
.long 0x3c00,0xbc00,0x0,0x0,0xb61f3c00,0x3b64b9a8,0x0,0x0
.long 0xb9a83c00,0x39a80000,0x0,0x0,0xbb643c00,0xb61f39a8,0x0,0x0
.long 0x0,0x0,0x3bd93c00,0x3aa73b64,0x0,0x0,0x3aa73c00,0xb23e361f
.long 0x0,0x0,0x38723c00,0xbbd9b61f,0x0,0x0,0x323e3c00,0xb872bb64
.long 0x0,0x0,0xb23e3c00,0x3872bb64,0x0,0x0,0xb8723c00,0x3bd9b61f
.long 0x0,0x0,0xbaa73c00,0x323e361f,0x0,0x0,0xbbd93c00,0xbaa73b64
.long 0x3c003c00,0x3c003c00,0x0,0x0,0xb61f0000,0xbb64b9a8,0x0,0x0
.long 0xb9a8bc00,0x39a80000,0x0,0x0,0x3b640000,0xb61f39a8,0x0,0x0
.long 0x3c00,0xbc00,0x0,0x0,0xbb640000,0x361f39a8,0x0,0x0
.long 0x39a8bc00,0xb9a80000,0x0,0x0,0x361f0000,0x3b64b9a8,0x0,0x0
.long 0x0,0x0,0x387239a8,0x323e361f,0x0,0x0,0xbbd9b9a8,0xb872bb64
.long 0x0,0x0,0x323eb9a8,0x3aa73b64,0x0,0x0,0x3aa739a8,0xbbd9b61f
.long 0x0,0x0,0xbaa739a8,0x3bd9b61f,0x0,0x0,0xb23eb9a8,0xbaa73b64
.long 0x0,0x0,0x3bd9b9a8,0x3872bb64,0x0,0x0,0xb87239a8,0xb23e361f
.long 0x3c003c00,0x3c003c00,0x0,0x0,0xbb64bc00,0xb61fb9a8,0x0,0x0
.long 0x39a83c00,0xb9a80000,0x0,0x0,0xb61fbc00,0x3b6439a8,0x0,0x0
.long 0x3c00,0xbc00,0x0,0x0,0x361fbc00,0xbb6439a8,0x0,0x0
.long 0xb9a83c00,0x39a80000,0x0,0x0,0x3b64bc00,0x361fb9a8,0x0,0x0
.long 0x0,0x0,0xb23e0000,0xb872b61f,0x0,0x0,0x38720000,0x3bd93b64
.long 0x0,0x0,0xbaa70000,0xb23ebb64,0x0,0x0,0x3bd90000,0xbaa7361f
.long 0x0,0x0,0xbbd90000,0x3aa7361f,0x0,0x0,0x3aa70000,0x323ebb64
.long 0x0,0x0,0xb8720000,0xbbd93b64,0x0,0x0,0x323e0000,0x3872b61f
.long 0x3c003c00,0x3c003c00,0x0,0x0,0x361f0000,0x3b6439a8,0x0,0x0
.long 0xb9a8bc00,0x39a80000,0x0,0x0,0xbb640000,0x361fb9a8,0x0,0x0
.long 0x3c00,0xbc00,0x0,0x0,0x3b640000,0xb61fb9a8,0x0,0x0
.long 0x39a8bc00,0xb9a80000,0x0,0x0,0xb61f0000,0xbb6439a8,0x0,0x0
.long 0x0,0x0,0xbaa7b9a8,0xbbd9bb64,0x0,0x0,0x323e39a8,0xbaa7b61f
.long 0x0,0x0,0x3bd939a8,0xb872361f,0x0,0x0,0x3872b9a8,0xb23e3b64
.long 0x0,0x0,0xb872b9a8,0x323e3b64,0x0,0x0,0xbbd939a8,0x3872361f
.long 0x0,0x0,0xb23e39a8,0x3aa7b61f,0x0,0x0,0x3aa7b9a8,0x3bd9bb64
.long 0xbc003c00,0xbc003c00,0x0,0x0,0xb61f8000,0xbb64b9a8,0x0,0x0
.long 0xb9a88000,0xb9a8bc00,0x0,0x0,0xbb648000,0x361fb9a8,0x0,0x0
.long 0xbc008000,0x3c008000,0x0,0x0,0xbb648000,0x361f39a8,0x0,0x0
.long 0xb9a88000,0xb9a83c00,0x0,0x0,0xb61f8000,0xbb6439a8,0x0,0x0
.long 0x0,0x0,0xb23e8000,0xb872b61f,0x0,0x0,0xb8728000,0xbbd9bb64
.long 0x0,0x0,0xbaa78000,0xb23ebb64,0x0,0x0,0xbbd98000,0x3aa7b61f
.long 0x0,0x0,0xbbd98000,0x3aa7361f,0x0,0x0,0xbaa78000,0xb23e3b64
.long 0x0,0x0,0xb8728000,0xbbd93b64,0x0,0x0,0xb23e8000,0xb872361f
.long 0xbc003c00,0xbc003c00,0x0,0x0,0xbb64bc00,0xb61fb9a8,0x0,0x0
.long 0x39a88000,0x39a83c00,0x0,0x0,0x361f3c00,0xbb64b9a8,0x0,0x0
.long 0xbc008000,0x3c008000,0x0,0x0,0x361fbc00,0xbb6439a8,0x0,0x0
.long 0x39a88000,0x39a8bc00,0x0,0x0,0xbb643c00,0xb61f39a8,0x0,0x0
.long 0x0,0x0,0xbaa7b9a8,0xbbd9bb64,0x0,0x0,0xb23eb9a8,0x3aa7361f
.long 0x0,0x0,0x3bd939a8,0xb872361f,0x0,0x0,0xb87239a8,0x323ebb64
.long 0x0,0x0,0xb872b9a8,0x323e3b64,0x0,0x0,0x3bd9b9a8,0xb872b61f
.long 0x0,0x0,0xb23e39a8,0x3aa7b61f,0x0,0x0,0xbaa739a8,0xbbd93b64
.long 0xbc003c00,0xbc003c00,0x0,0x0,0x361f8000,0x3b6439a8,0x0,0x0
.long 0xb9a88000,0xb9a8bc00,0x0,0x0,0x3b648000,0xb61f39a8,0x0,0x0
.long 0xbc008000,0x3c008000,0x0,0x0,0x3b648000,0xb61fb9a8,0x0,0x0
.long 0xb9a88000,0xb9a83c00,0x0,0x0,0x361f8000,0x3b64b9a8,0x0,0x0
.long 0x0,0x0,0xbbd9bc00,0xbaa7bb64,0x0,0x0,0x3aa73c00,0xb23e361f
.long 0x0,0x0,0xb872bc00,0x3bd9361f,0x0,0x0,0x323e3c00,0xb872bb64
.long 0x0,0x0,0x323ebc00,0xb8723b64,0x0,0x0,0xb8723c00,0x3bd9b61f
.long 0x0,0x0,0x3aa7bc00,0xb23eb61f,0x0,0x0,0xbbd93c00,0xbaa73b64
.long 0xbc003c00,0xbc003c00,0x0,0x0,0x3b643c00,0x361f39a8,0x0,0x0
.long 0x39a88000,0x39a83c00,0x0,0x0,0xb61fbc00,0x3b6439a8,0x0,0x0
.long 0xbc008000,0x3c008000,0x0,0x0,0xb61f3c00,0x3b64b9a8,0x0,0x0
.long 0x39a88000,0x39a8bc00,0x0,0x0,0x3b64bc00,0x361fb9a8,0x0,0x0
.long 0x0,0x0,0xb872b9a8,0xb23eb61f,0x0,0x0,0xbbd9b9a8,0xb872bb64
.long 0x0,0x0,0xb23e39a8,0xbaa7bb64,0x0,0x0,0x3aa739a8,0xbbd9b61f
.long 0x0,0x0,0x3aa7b9a8,0xbbd9361f,0x0,0x0,0xb23eb9a8,0xbaa73b64
.long 0x0,0x0,0xbbd939a8,0xb8723b64,0x0,0x0,0xb87239a8,0xb23e361f
TEXT_END:
.section .rodata,"a"
.p2align 6
.amdhsa_kernel parallel_sum__spectral_gfnet__dense_activation_silu__prompt_kernel
  .amdhsa_next_free_vgpr 256
  .amdhsa_next_free_sgpr 102
  .amdhsa_accum_offset 256
  .amdhsa_group_segment_fixed_size 0
  .amdhsa_kernarg_size 72
  .amdhsa_user_sgpr_count 2
  .amdhsa_user_sgpr_kernarg_segment_ptr 1
  .amdhsa_system_sgpr_workgroup_id_x 1
.end_amdhsa_kernel
```
